```python
import torch

def _softmax(x, axis=-1):
    return torch.softmax(x, dim=axis)
def _gelu(x):
    return torch.nn.functional.gelu(x, approximate="tanh")
def _silu(x):
    return torch.nn.functional.silu(x)
def _sigmoid(x):
    return torch.sigmoid(x)
def _layernorm(x, axis=-1, eps=1e-5):
    m = x.mean(dim=axis, keepdim=True)
    v = x.var(dim=axis, keepdim=True, unbiased=False)
    return (x - m) / torch.sqrt(v + eps)
def _scatter_add(tgt, idx, src, axis=0):
    return tgt.clone().index_add_(axis, idx, src)
def _segment_sum(src, seg, n):
    out = torch.zeros((n,) + src.shape[1:], dtype=src.dtype)
    return out.index_add_(0, seg, src)
def _pad(x, pw):
    flat = tuple(v for pair in reversed(pw) for v in pair)
    return torch.nn.functional.pad(x, flat)

kernel_name = 'gated_mix__sliding_local_dilated__dense_activation_squared_relu__prompt'

def setup_inputs():

    _w = (lambda a: (lambda t: t.to(torch.bfloat16) if t.is_floating_point() else t)(torch.as_tensor(a)))
    def _A_setup():
        B, S, D = 1, 2048, 1024
        return {
            "x": _w((lambda *s: torch.randn(*s, dtype=torch.bfloat16) * 0.05)(B, S, D)),
            "wqkv": _w((lambda *s: torch.randn(*s, dtype=torch.bfloat16) * 0.8)(D, 3 * D)),
            "wo": _w((lambda *s: torch.randn(*s, dtype=torch.bfloat16) * 0.05)(D, D)),
        }
    _A_in = _A_setup()

    def _B_setup():
        B, S, D, F = 1, 2048, 1024, 3584
        return {
            "x": _w((lambda *s: torch.randn(*s, dtype=torch.bfloat16) * 0.05)(B, S, D)),
            "w1": _w((lambda *s: torch.randn(*s, dtype=torch.bfloat16) * 0.1)(D, F)),
            "b1": _w((lambda *s: torch.randn(*s, dtype=torch.bfloat16) * 0.2)(F)),
            "w2": _w((lambda *s: torch.randn(*s, dtype=torch.bfloat16) * 0.1)(F, D)),
            "b2": _w((lambda *s: torch.randn(*s, dtype=torch.bfloat16) * 0.4)(D)),
        }
    _B_in = _B_setup()

    return {
        "A_x": _A_in["x"],
        "A_wqkv": _A_in["wqkv"],
        "A_wo": _A_in["wo"],
        "B_x": _B_in["x"],
        "B_w1": _B_in["w1"],
        "B_b1": _B_in["b1"],
        "B_w2": _B_in["w2"],
        "B_b2": _B_in["b2"],
        "gate_w": _w((lambda *s: torch.randn(*s, dtype=torch.bfloat16) * 0.05)(1024) * 16.0),
    }

def reference(A_x, A_wqkv, A_wo, B_x, B_w1, B_b1, B_w2, B_b2, gate_w):
    def _A_ref(x, wqkv, wo):
        B, S, D = x.shape
        H = 32; Dh = D // H
        W, dil = 8, 2
        qkv = (lambda x, *d: x.permute(*d))((x @ wqkv).reshape(B, S, 3, H, Dh), 2, 0, 3, 1, 4)
        q, k, v = qkv[0], qkv[1], qkv[2]
        scale = Dh ** -0.5
        pos = torch.arange(S)
        off = torch.arange(W) * dil
        idx = pos[:, None] - off[None, :]
        mask = idx >= 0
        idx_c = torch.where(mask, idx, 0).reshape(-1)
        kg = k[:, :, idx_c, :].reshape(B, H, S, W, Dh)
        vg = v[:, :, idx_c, :].reshape(B, H, S, W, Dh)
        logits = torch.einsum("bhsd,bhswd->bhsw", q, kg) * scale
        logits = torch.where(mask[None, None, :, :], logits, -1e9)
        attn = _softmax(logits, axis=-1)
        o = torch.einsum("bhsw,bhswd->bhsd", attn, vg)
        return (lambda x, *d: x.permute(*d))(o, 0, 2, 1, 3).reshape(B, S, D) @ wo

    def _B_ref(x, w1, b1, w2, b2):
        h = torch.einsum("bsd,df->bsf", x, w1) + b1
        zero = torch.zeros_like(h)
        r = torch.where(h > zero, h, zero)
        h = r * r
        out = torch.einsum("bsf,fd->bsd", h, w2) + b2
        return out

    x = A_x
    g = _sigmoid((x * gate_w).sum(-1, keepdims=True))
    a = _A_ref(x, A_wqkv, A_wo)
    b = _B_ref(x, B_w1, B_b1, B_w2, B_b2)
    return g * a + (1 - g) * b
```

```asm
; @launch grid=(256,1,1) block=(256,1,1) lds=163840
.amdgcn_target "amdgcn-amd-amdhsa--gfx950"
.text
.globl gated_mix__sliding_local_dilated__dense_activation_squared_relu__prompt_kernel
.p2align 8
.type gated_mix__sliding_local_dilated__dense_activation_squared_relu__prompt_kernel,@function
gated_mix__sliding_local_dilated__dense_activation_squared_relu__prompt_kernel:
s_cmp_ge_u32 s2, 256
s_cbranch_scc1 L_exit
s_load_dwordx4 s[4:7], s[0:1], 0
s_load_dwordx4 s[24:27], s[0:1], 32
s_load_dwordx4 s[20:23], s[0:1], 80
s_load_dwordx4 s[72:75], s[0:1], 16
s_load_dwordx4 s[60:63], s[0:1], 48
s_load_dwordx4 s[56:59], s[0:1], 64
s_getpc_b64 s[40:41]
L_pc:
s_lshr_b32 s42, s2, 3
s_mul_i32 s42, s42, (L_code_end - gated_mix__sliding_local_dilated__dense_activation_squared_relu__prompt_kernel + 4095) / 4096
v_add_u32 v2, s42, v0
v_lshlrev_b32 v2, 7, v2
v_cmp_gt_u32 vcc, (L_code_end - gated_mix__sliding_local_dilated__dense_activation_squared_relu__prompt_kernel + 4095) / 4096, v0
s_mov_b32 s43, L_code_end - L_pc - 4
v_cmp_gt_u32 s[44:45], s43, v2
s_nop 3
s_and_b64 vcc, vcc, s[44:45]
s_and_saveexec_b64 s[44:45], vcc
s_cbranch_execz L_nopc
global_load_dword v24, v2, s[40:41]
L_nopc:
s_mov_b64 exec, s[44:45]
v_lshrrev_b32 v1, 6, v0
v_and_b32 v0, 63, v0
s_nop 0
v_readfirstlane_b32 s28, v1
s_nop 3
s_lshr_b32 s29, s28, 1
s_and_b32 s30, s28, 1
s_and_b32 s34, s2, 7
s_lshr_b32 s35, s2, 3
s_and_b32 s36, s34, 1
s_lshl_b32 s36, s36, 2
s_lshr_b32 s37, s35, 2
s_and_b32 s37, s37, 3
s_add_u32 s31, s36, s37
s_lshr_b32 s34, s34, 1
s_lshl_b32 s34, s34, 2
s_and_b32 s36, s35, 3
s_add_u32 s32, s34, s36
s_cmp_ge_u32 s35, 16
s_cbranch_scc1 L_w1
L_qkv:
s_lshl_b32 s65, s32, 7
s_mov_b32 s40, 0
v_lshrrev_b32 v14, 3, v0
v_and_b32 v15, 7, v0
v_and_b32 v16, 6, v14
v_xor_b32 v16, v15, v16
v_lshlrev_b32 v16, 4, v16
v_lshlrev_b32 v17, 12, v14
v_add_u32 v17, v17, v16
s_lshl_b32 s50, s28, 17
v_add_u32 v17, s50, v17
v_add_u32 v1, 0, v17
v_add_u32 v2, 31744, v17
v_add_u32 v3, 0, v17
v_add_u32 v4, 31744, v17
s_lshl_b32 s53, s28, 13
s_add_u32 s53, s53, 49152
s_lshl_b32 s52, s31, 19
s_lshl_b32 s54, s30, 10
s_add_u32 s54, s54, 81920
s_add_u32 s41, s40, s52
s_add_u32 s42, s41, 65536
s_mov_b32 s47, 0
s_add_u32 s44, s47, s53
s_add_u32 s45, s44, 4096
s_add_u32 s46, s47, s54
v_lshlrev_b32 v25, 1, v14
s_lshl_b32 s50, s31, 8
s_sub_u32 s50, s50, s30
s_sub_u32 s50, s50, 15
v_add_u32 v25, s50, v25
v_max_i32 v25, 0, v25
v_lshlrev_b32 v25, 11, v25
v_add_u32 v8, v25, v16
s_and_b32 s50, s28, 1
s_lshl_b32 s50, s50, 2
v_and_b32 v18, 2, v14
v_or_b32 v18, s50, v18
v_xor_b32 v18, v15, v18
v_lshlrev_b32 v18, 4, v18
s_lshl_b32 s50, s28, 3
v_add_u32 v19, s50, v14
v_mul_u32_u24 v19, 6144, v19
v_add_u32 v19, v19, v18
s_add_u32 s50, s65, 4096
v_add_u32 v5, s50, v19
s_add_u32 s50, s65, 5120
v_add_u32 v6, s50, v19
s_add_u32 s50, s65, 6144
v_add_u32 v7, s50, v19
s_mul_i32 s34, s28, 3072
s_mul_i32 s35, s28, 3072
s_add_u32 s35, s35, 12288
s_mul_i32 s36, s28, 3072
s_add_u32 s36, s36, 24576
s_mul_i32 s37, s28, 3072
s_add_u32 s37, s37, 36864
s_waitcnt lgkmcnt(0)
s_mov_b32 s8, s4
s_mov_b32 s9, s5
s_mov_b32 s10, 4194304
s_mov_b32 s11, 0x00020000
s_mov_b32 m0, s44
s_nop 0
buffer_load_dwordx4 v1, s[8:11], s41 offen offset:0 lds
buffer_load_dwordx4 v2, s[8:11], s41 offen offset:1024 lds
buffer_load_dwordx4 v3, s[8:11], s41 offen offset:2048 lds
buffer_load_dwordx4 v4, s[8:11], s41 offen offset:3072 lds
s_mov_b32 m0, s45
s_nop 0
buffer_load_dwordx4 v1, s[8:11], s42 offen offset:0 lds
buffer_load_dwordx4 v2, s[8:11], s42 offen offset:1024 lds
buffer_load_dwordx4 v3, s[8:11], s42 offen offset:2048 lds
buffer_load_dwordx4 v4, s[8:11], s42 offen offset:3072 lds
s_mov_b32 m0, s46
s_nop 0
buffer_load_dwordx4 v8, s[8:11], s40 offen lds
s_sub_u32 s12, s6, 4096
s_subb_u32 s13, s7, 0
s_mov_b32 s14, 6295552
s_mov_b32 s15, 0x00020000
s_lshr_b32 s38, s40, 1
s_mul_i32 s39, s38, 6144
s_mov_b32 m0, s34
s_nop 0
buffer_load_dwordx4 v5, s[12:15], s39 offen offset:0 lds
buffer_load_dwordx4 v6, s[12:15], s39 offen offset:1024 lds
buffer_load_dwordx4 v7, s[12:15], s39 offen offset:2048 lds
s_add_u32 s38, s38, 32
s_and_b32 s38, s38, 1023
s_mul_i32 s39, s38, 6144
s_mov_b32 m0, s35
s_nop 0
buffer_load_dwordx4 v5, s[12:15], s39 offen offset:0 lds
buffer_load_dwordx4 v6, s[12:15], s39 offen offset:1024 lds
buffer_load_dwordx4 v7, s[12:15], s39 offen offset:2048 lds
s_mov_b32 s100, s20
s_mov_b32 s101, s21
s_mov_b32 s16, s22
s_mov_b32 s17, s23
s_mov_b32 s18, 32112640
s_mov_b32 s19, 0x00020000
s_mov_b32 s20, s56
s_mov_b32 s21, s57
s_mov_b32 s22, 2048
s_mov_b32 s23, 0x00020000
s_add_u32 s40, s40, 128
s_and_b32 s40, s40, 2047
s_add_u32 s41, s40, s52
s_add_u32 s42, s41, 65536
s_mov_b32 s47, 34816
s_add_u32 s44, s47, s53
s_add_u32 s45, s44, 4096
s_add_u32 s46, s47, s54
s_mov_b32 m0, s44
s_nop 0
buffer_load_dwordx4 v1, s[8:11], s41 offen offset:0 lds
v_and_b32 v21, 15, v0
v_lshrrev_b32 v20, 4, v0
v_and_b32 v22, 6, v21
v_xor_b32 v22, v20, v22
v_lshlrev_b32 v22, 4, v22
v_lshlrev_b32 v23, 7, v21
v_add_u32 v22, v22, v23
s_lshl_b32 s51, s29, 14
s_add_u32 s51, s51, 49152
v_add_u32 v9, s51, v22
v_xor_b32 v10, 64, v9
v_lshrrev_b32 v14, 2, v0
v_and_b32 v14, 3, v14
v_and_b32 v15, 3, v0
v_lshrrev_b32 v16, 1, v15
v_and_b32 v17, 2, v14
v_and_b32 v18, 1, v20
v_lshlrev_b32 v19, 2, v18
v_or_b32 v17, v17, v19
buffer_load_dwordx4 v2, s[8:11], s41 offen offset:1024 lds
v_mul_u32_u24 v19, 3072, v20
v_lshlrev_b32 v23, 7, v14
v_add_u32 v19, v19, v23
v_and_b32 v23, 1, v15
v_lshlrev_b32 v23, 3, v23
v_add_u32 v19, v19, v23
s_lshl_b32 s51, s30, 2
s_add_u32 s51, s51, 0
v_or_b32 v23, s51, v16
v_xor_b32 v23, v23, v17
v_lshlrev_b32 v23, 4, v23
v_add_u32 v11, v19, v23
s_lshl_b32 s51, s30, 2
s_add_u32 s51, s51, 2
v_or_b32 v23, s51, v16
v_xor_b32 v23, v23, v17
v_lshlrev_b32 v23, 4, v23
v_add_u32 v12, v19, v23
s_mov_b32 s92, s72
buffer_load_dwordx4 v3, s[8:11], s41 offen offset:2048 lds
s_mov_b32 s93, s73
s_mov_b32 s94, 2097152
s_mov_b32 s95, 0x00020000
s_mov_b32 s96, s60
s_mov_b32 s97, s61
s_mov_b32 s98, 7340032
s_mov_b32 s99, 0x00020000
s_lshl_b32 s51, s2, 2
s_add_u32 s51, s51, s28
s_mul_i32 s71, s51, 7168
v_lshlrev_b32 v30, 7, v0
v_mov_b32 v28, 0x7ff00000
v_cmp_gt_u32 vcc, 56, v0
v_lshlrev_b32 v29, 7, v0
s_lshl_b32 s55, s51, 11
v_cndmask_b32 v30, v28, v30, vcc
v_cmp_gt_u32 vcc, 16, v0
s_nop 1
v_cndmask_b32 v29, v28, v29, vcc
buffer_load_dwordx4 v4, s[8:11], s41 offen offset:3072 lds
v_and_b32 v14, 15, v0
v_lshrrev_b32 v15, 4, v0
v_lshlrev_b32 v15, 2, v15
v_add_u32 v16, 9, v14
v_subrev_u32 v19, 7, v14
v_mov_b32 v21, 0xf149f2ca
s_or_b32 s51, s31, s29
v_add_u32 v20, 0, v15
v_cmp_ge_i32 s[56:57], v20, v16
v_cmp_ge_i32 vcc, v20, v19
v_cmp_le_i32 s[72:73], v20, v14
s_nop 1
s_and_b64 s[72:73], s[72:73], vcc
s_or_b64 s[74:75], s[72:73], s[56:57]
v_cndmask_b32 v32, v21, 0, s[74:75]
s_cmp_eq_u32 s51, 0
s_cselect_b64 s[74:75], s[72:73], s[74:75]
v_cndmask_b32 v36, v21, 0, s[74:75]
v_add_u32 v20, 1, v15
s_add_u32 s38, s38, 32
s_and_b32 s38, s38, 1023
s_mul_i32 s39, s38, 6144
s_mov_b32 m0, s36
s_nop 0
buffer_load_dwordx4 v5, s[12:15], s39 offen offset:0 lds
v_cmp_ge_i32 s[58:59], v20, v16
v_cmp_ge_i32 vcc, v20, v19
v_cmp_le_i32 s[72:73], v20, v14
s_nop 1
s_and_b64 s[72:73], s[72:73], vcc
s_or_b64 s[74:75], s[72:73], s[58:59]
v_cndmask_b32 v33, v21, 0, s[74:75]
s_cmp_eq_u32 s51, 0
s_cselect_b64 s[74:75], s[72:73], s[74:75]
v_cndmask_b32 v37, v21, 0, s[74:75]
v_add_u32 v20, 2, v15
v_cmp_ge_i32 s[60:61], v20, v16
v_cmp_ge_i32 vcc, v20, v19
v_cmp_le_i32 s[72:73], v20, v14
s_nop 1
s_and_b64 s[72:73], s[72:73], vcc
s_or_b64 s[74:75], s[72:73], s[60:61]
v_cndmask_b32 v34, v21, 0, s[74:75]
s_cmp_eq_u32 s51, 0
s_cselect_b64 s[74:75], s[72:73], s[74:75]
buffer_load_dwordx4 v6, s[12:15], s39 offen offset:1024 lds
v_cndmask_b32 v38, v21, 0, s[74:75]
v_add_u32 v20, 3, v15
v_cmp_ge_i32 s[62:63], v20, v16
v_cmp_ge_i32 vcc, v20, v19
v_cmp_le_i32 s[72:73], v20, v14
s_nop 1
s_and_b64 s[72:73], s[72:73], vcc
s_or_b64 s[74:75], s[72:73], s[62:63]
v_cndmask_b32 v35, v21, 0, s[74:75]
s_cmp_eq_u32 s51, 0
s_cselect_b64 s[74:75], s[72:73], s[74:75]
v_cndmask_b32 v39, v21, 0, s[74:75]
v_mov_b32 v22, 0xffff
v_mov_b32 v23, 0xffff0000
v_cndmask_b32 v20, 0, v22, s[56:57]
v_cndmask_b32 v21, 0, v23, s[58:59]
v_or_b32 v40, v20, v21
v_not_b32 v42, v40
v_cndmask_b32 v20, 0, v22, s[60:61]
buffer_load_dwordx4 v7, s[12:15], s39 offen offset:2048 lds
v_cndmask_b32 v21, 0, v23, s[62:63]
v_or_b32 v41, v20, v21
v_not_b32 v43, v41
v_mov_b32 v44, 0x3f803f80
v_mov_b32 v45, 0x3f803f80
v_mov_b32 v46, 0x3f803f80
v_mov_b32 v47, 0x3f803f80
s_mov_b32 s68, 0x3e8293ee
s_mov_b32 s69, 0x3e8293ee
v_mov_b64 v[48:49], 0
v_mov_b64 v[50:51], 0
v_mov_b64 v[52:53], 0
v_mov_b64 v[54:55], 0
v_mov_b64 v[56:57], 0
v_mov_b64 v[58:59], 0
v_mov_b64 v[60:61], 0
v_mov_b64 v[62:63], 0
v_mov_b64 v[64:65], 0
v_mov_b64 v[66:67], 0
s_mov_b32 m0, s45
s_nop 0
buffer_load_dwordx4 v1, s[8:11], s42 offen offset:0 lds
v_mov_b64 v[68:69], 0
v_mov_b64 v[70:71], 0
v_mov_b64 v[72:73], 0
v_mov_b64 v[74:75], 0
v_mov_b64 v[76:77], 0
v_mov_b64 v[78:79], 0
v_mov_b64 v[80:81], 0
v_mov_b64 v[82:83], 0
v_mov_b64 v[84:85], 0
v_mov_b64 v[86:87], 0
v_mov_b64 v[88:89], 0
v_mov_b64 v[90:91], 0
v_mov_b64 v[92:93], 0
v_mov_b64 v[94:95], 0
v_mov_b64 v[96:97], 0
v_mov_b64 v[98:99], 0
v_mov_b64 v[100:101], 0
v_mov_b64 v[102:103], 0
v_mov_b64 v[104:105], 0
buffer_load_dwordx4 v2, s[8:11], s42 offen offset:1024 lds
v_mov_b64 v[106:107], 0
v_mov_b64 v[108:109], 0
v_mov_b64 v[110:111], 0
v_mov_b64 v[112:113], 0
v_mov_b64 v[114:115], 0
v_mov_b64 v[116:117], 0
v_mov_b64 v[118:119], 0
v_mov_b64 v[120:121], 0
v_mov_b64 v[122:123], 0
v_mov_b64 v[124:125], 0
v_mov_b64 v[126:127], 0
v_mov_b64 v[128:129], 0
v_mov_b64 v[130:131], 0
v_mov_b64 v[132:133], 0
v_mov_b64 v[134:135], 0
v_mov_b64 v[136:137], 0
v_mov_b64 v[138:139], 0
v_mov_b64 v[140:141], 0
v_mov_b64 v[142:143], 0
buffer_load_dwordx4 v3, s[8:11], s42 offen offset:2048 lds
v_mov_b64 v[144:145], 0
v_mov_b64 v[146:147], 0
v_mov_b64 v[148:149], 0
v_mov_b64 v[150:151], 0
v_mov_b64 v[152:153], 0
v_mov_b64 v[154:155], 0
v_mov_b64 v[156:157], 0
v_mov_b64 v[158:159], 0
v_mov_b64 v[160:161], 0
v_mov_b64 v[162:163], 0
v_mov_b64 v[164:165], 0
v_mov_b64 v[166:167], 0
v_mov_b64 v[168:169], 0
v_mov_b64 v[170:171], 0
v_mov_b64 v[172:173], 0
v_mov_b64 v[174:175], 0
v_mov_b64 v[176:177], 0
v_mov_b64 v[178:179], 0
v_mov_b64 v[180:181], 0
buffer_load_dwordx4 v4, s[8:11], s42 offen offset:3072 lds
v_mov_b64 v[182:183], 0
v_mov_b64 v[184:185], 0
v_mov_b64 v[186:187], 0
v_mov_b64 v[188:189], 0
v_mov_b64 v[190:191], 0
v_mov_b64 v[192:193], 0
v_mov_b64 v[194:195], 0
v_mov_b64 v[196:197], 0
v_mov_b64 v[198:199], 0
v_mov_b64 v[200:201], 0
v_mov_b64 v[202:203], 0
v_mov_b64 v[204:205], 0
v_mov_b64 v[206:207], 0
v_mov_b64 v[208:209], 0
v_mov_b64 v[210:211], 0
v_mov_b64 v[212:213], 0
v_mov_b64 v[214:215], 0
v_mov_b64 v[216:217], 0
v_mov_b64 v[218:219], 0
s_mov_b32 m0, s46
s_nop 0
buffer_load_dwordx4 v8, s[8:11], s40 offen lds
v_mov_b64 v[220:221], 0
v_mov_b64 v[222:223], 0
v_mov_b64 v[224:225], 0
v_mov_b64 v[226:227], 0
v_mov_b64 v[228:229], 0
v_mov_b64 v[230:231], 0
v_mov_b64 v[232:233], 0
v_mov_b64 v[234:235], 0
v_mov_b64 v[236:237], 0
v_mov_b64 v[238:239], 0
v_mov_b64 v[240:241], 0
v_mov_b64 v[242:243], 0
v_mov_b64 v[244:245], 0
v_mov_b64 v[246:247], 0
s_cmp_eq_u32 s29, 1
s_cbranch_scc1 L_qkv_m1
s_waitcnt vmcnt(15)
s_mov_b32 s4, s100
s_mov_b32 s5, s101
s_mov_b32 s6, 256
s_mov_b32 s7, 0x00020000
s_lshr_b32 s24, s2, 3
s_and_b32 s24, s24, 7
s_cmp_eq_u32 s28, 0
s_cselect_b32 s24, s24, -1
s_lshr_b32 s25, s2, 3
s_and_b32 s25, s25, 3
s_add_u32 s25, s25, 3
v_mov_b32 v17, 1
v_mov_b32 v18, 0
s_lshl_b32 s27, s32, 3
s_add_u32 s27, s27, s31
v_mul_u32_u24 v31, 43, v0
v_lshrrev_b32 v31, 8, v31
v_mul_u32_u24 v14, 6, v31
v_sub_u32 v14, v0, v14
s_lshl_b32 s50, s27, 3
v_add_u32 v31, s50, v31
v_mul_u32_u24 v31, 6144, v31
v_lshlrev_b32 v14, 10, v14
v_add_u32 v31, v31, v14
v_add_u32 v31, 4480, v31
v_mov_b32 v14, 0x7ff00000
v_cmp_gt_u32 vcc, 48, v0
s_lshr_b32 s27, s27, 4
s_max_u32 s27, s27, 1
v_cndmask_b32 v31, v14, v31, vcc
s_sub_u32 s27, s27, 1
s_cmp_eq_u32 s28, 1
s_cselect_b32 s27, s27, -1
s_barrier
ds_read_b64_tr_b16 a[80:81], v11 offset:0
ds_read_b128 a[0:3], v9 offset:0
ds_read_b64_tr_b16 a[82:83], v11 offset:512
ds_read_b128 a[4:7], v9 offset:2048
ds_read_b64_tr_b16 a[84:85], v12 offset:0
ds_read_b128 a[8:11], v9 offset:4096
ds_read_b64_tr_b16 a[86:87], v12 offset:512
ds_read_b64_tr_b16 a[88:89], v11 offset:1024
ds_read_b128 a[12:15], v9 offset:6144
ds_read_b64_tr_b16 a[90:91], v11 offset:1536
ds_read_b128 a[16:19], v9 offset:8192
ds_read_b64_tr_b16 a[92:93], v12 offset:1024
ds_read_b128 a[20:23], v9 offset:10240
ds_read_b64_tr_b16 a[94:95], v12 offset:1536
ds_read_b64_tr_b16 a[96:97], v11 offset:2048
ds_read_b128 a[24:27], v9 offset:12288
ds_read_b64_tr_b16 a[98:99], v11 offset:2560
ds_read_b128 a[28:31], v9 offset:14336
ds_read_b64_tr_b16 a[100:101], v12 offset:2048
ds_read_b128 a[32:35], v9 offset:32768
ds_read_b64_tr_b16 a[102:103], v12 offset:2560
s_add_u32 s38, s38, 32
s_and_b32 s38, s38, 1023
s_mul_i32 s39, s38, 6144
s_mov_b32 m0, s37
s_nop 0
buffer_load_dwordx4 v5, s[12:15], s39 offen offset:0 lds
buffer_load_dwordx4 v6, s[12:15], s39 offen offset:1024 lds
buffer_load_dwordx4 v7, s[12:15], s39 offen offset:2048 lds
s_add_u32 s40, s40, 128
s_and_b32 s40, s40, 2047
s_add_u32 s41, s40, s52
s_add_u32 s42, s41, 65536
s_mov_b32 s47, 69632
s_add_u32 s44, s47, s53
s_add_u32 s45, s44, 4096
s_add_u32 s46, s47, s54
s_mov_b32 m0, s44
s_nop 0
buffer_load_dwordx4 v1, s[8:11], s41 offen offset:0 lds
buffer_load_dwordx4 v2, s[8:11], s41 offen offset:1024 lds
buffer_load_dwordx4 v3, s[8:11], s41 offen offset:2048 lds
buffer_load_dwordx4 v4, s[8:11], s41 offen offset:3072 lds
s_mov_b32 s47, 0
s_lshl_b32 s50, s2, 7
s_add_u32 s50, s50, 23625728
v_mov_b32 v14, 0
v_lshlrev_b32 v15, 2, v0
v_and_b32 v15, 127, v15
buffer_store_dword v14, v15, s[16:19], s50 offen sc1
s_waitcnt vmcnt(20) lgkmcnt(0)
s_barrier
s_mov_b32 s33, 0
L_loop_qkv0:
s_cmp_eq_u32 s33, 7
s_cselect_b32 s10, 0, s10
s_cselect_b32 s14, 0, s14
v_mfma_f32_16x16x32_bf16 v[48:51], a[80:83], a[0:3], v[48:51]
ds_read_b64_tr_b16 a[108:109], v11 offset:12288
v_mfma_f32_16x16x32_bf16 v[52:55], a[80:83], a[4:7], v[52:55]
v_mfma_f32_16x16x32_bf16 v[56:59], a[80:83], a[8:11], v[56:59]
ds_read_b128 a[40:43], v10 offset:0
v_mfma_f32_16x16x32_bf16 v[60:63], a[80:83], a[12:15], v[60:63]
v_mfma_f32_16x16x32_bf16 v[64:67], a[80:83], a[16:19], v[64:67]
ds_read_b64_tr_b16 a[110:111], v11 offset:12800
v_mfma_f32_16x16x32_bf16 v[68:71], a[80:83], a[20:23], v[68:71]
v_mfma_f32_16x16x32_bf16 v[72:75], a[80:83], a[24:27], v[72:75]
ds_read_b128 a[44:47], v10 offset:2048
v_mfma_f32_16x16x32_bf16 v[76:79], a[80:83], a[28:31], v[76:79]
v_mfma_f32_16x16x32_bf16 v[80:83], a[84:87], a[0:3], v[80:83]
ds_read_b64_tr_b16 a[112:113], v12 offset:12288
s_add_u32 s38, s38, 32
s_and_b32 s38, s38, 1023
s_mul_i32 s39, s38, 6144
s_mov_b32 m0, s34
v_mfma_f32_16x16x32_bf16 v[84:87], a[84:87], a[4:7], v[84:87]
v_mfma_f32_16x16x32_bf16 v[88:91], a[84:87], a[8:11], v[88:91]
ds_read_b128 a[48:51], v10 offset:4096
s_cmp_eq_u32 s33, s25
s_cbranch_scc0 L_nopf_qkv0
buffer_load_dword v28, v30, s[96:99], s71 offen
buffer_load_dword v28, v29, s[92:95], s55 offen
L_nopf_qkv0:
v_mfma_f32_16x16x32_bf16 v[92:95], a[84:87], a[12:15], v[92:95]
v_mfma_f32_16x16x32_bf16 v[96:99], a[84:87], a[16:19], v[96:99]
buffer_load_dwordx4 v5, s[12:15], s39 offen offset:0 lds
ds_read_b64_tr_b16 a[114:115], v12 offset:12800
v_mfma_f32_16x16x32_bf16 v[100:103], a[84:87], a[20:23], v[100:103]
v_mfma_f32_16x16x32_bf16 v[104:107], a[84:87], a[24:27], v[104:107]
ds_read_b64_tr_b16 a[116:117], v11 offset:13312
v_mfma_f32_16x16x32_bf16 v[108:111], a[84:87], a[28:31], v[108:111]
v_mfma_f32_16x16x32_bf16 v[112:115], a[88:91], a[0:3], v[112:115]
buffer_load_dwordx4 v6, s[12:15], s39 offen offset:1024 lds
ds_read_b128 a[52:55], v10 offset:6144
v_mfma_f32_16x16x32_bf16 v[116:119], a[88:91], a[4:7], v[116:119]
v_mfma_f32_16x16x32_bf16 v[120:123], a[88:91], a[8:11], v[120:123]
ds_read_b64_tr_b16 a[118:119], v11 offset:13824
v_mfma_f32_16x16x32_bf16 v[124:127], a[88:91], a[12:15], v[124:127]
v_mfma_f32_16x16x32_bf16 v[128:131], a[88:91], a[16:19], v[128:131]
buffer_load_dwordx4 v7, s[12:15], s39 offen offset:2048 lds
ds_read_b128 a[56:59], v10 offset:8192
v_mfma_f32_16x16x32_bf16 v[132:135], a[88:91], a[20:23], v[132:135]
v_mfma_f32_16x16x32_bf16 v[136:139], a[88:91], a[24:27], v[136:139]
ds_read_b64_tr_b16 a[120:121], v12 offset:13312
v_mfma_f32_16x16x32_bf16 v[140:143], a[88:91], a[28:31], v[140:143]
s_mov_b32 m0, s45
v_mfma_f32_16x16x32_bf16 v[144:147], a[92:95], a[0:3], v[144:147]
ds_read_b128 a[60:63], v10 offset:10240
v_mfma_f32_16x16x32_bf16 v[148:151], a[92:95], a[4:7], v[148:151]
v_mfma_f32_16x16x32_bf16 v[152:155], a[92:95], a[8:11], v[152:155]
ds_read_b64_tr_b16 a[122:123], v12 offset:13824
v_mfma_f32_16x16x32_bf16 v[156:159], a[92:95], a[12:15], v[156:159]
buffer_load_dwordx4 v1, s[8:11], s42 offen offset:0 lds
v_mfma_f32_16x16x32_bf16 v[160:163], a[92:95], a[16:19], v[160:163]
ds_read_b64_tr_b16 a[124:125], v11 offset:14336
v_mfma_f32_16x16x32_bf16 v[164:167], a[92:95], a[20:23], v[164:167]
v_mfma_f32_16x16x32_bf16 v[168:171], a[92:95], a[24:27], v[168:171]
ds_read_b128 a[64:67], v10 offset:12288
v_mfma_f32_16x16x32_bf16 v[172:175], a[92:95], a[28:31], v[172:175]
buffer_load_dwordx4 v2, s[8:11], s42 offen offset:1024 lds
v_mfma_f32_16x16x32_bf16 v[176:179], a[0:3], a[96:99], v[176:179]
ds_read_b64_tr_b16 a[126:127], v11 offset:14848
v_mfma_f32_16x16x32_bf16 v[180:183], a[4:7], a[96:99], v[180:183]
v_mfma_f32_16x16x32_bf16 v[184:187], a[8:11], a[96:99], v[184:187]
ds_read_b128 a[68:71], v10 offset:14336
v_mfma_f32_16x16x32_bf16 v[188:191], a[12:15], a[96:99], v[188:191]
buffer_load_dwordx4 v3, s[8:11], s42 offen offset:2048 lds
v_mfma_f32_16x16x32_bf16 v[192:195], a[16:19], a[96:99], v[192:195]
ds_read_b64_tr_b16 a[128:129], v12 offset:14336
v_mfma_f32_16x16x32_bf16 v[196:199], a[20:23], a[96:99], v[196:199]
v_mfma_f32_16x16x32_bf16 v[200:203], a[24:27], a[96:99], v[200:203]
ds_read_b128 a[72:75], v10 offset:32768
v_mfma_f32_16x16x32_bf16 v[204:207], a[28:31], a[96:99], v[204:207]
buffer_load_dwordx4 v4, s[8:11], s42 offen offset:3072 lds
v_mfma_f32_16x16x32_bf16 v[208:211], a[0:3], a[100:103], v[208:211]
ds_read_b64_tr_b16 a[130:131], v12 offset:14848
v_mfma_f32_16x16x32_bf16 v[212:215], a[4:7], a[100:103], v[212:215]
v_mfma_f32_16x16x32_bf16 v[216:219], a[8:11], a[100:103], v[216:219]
s_mov_b32 m0, s46
v_mfma_f32_16x16x32_bf16 v[220:223], a[12:15], a[100:103], v[220:223]
v_mfma_f32_16x16x32_bf16 v[224:227], a[16:19], a[100:103], v[224:227]
v_mfma_f32_16x16x32_bf16 v[228:231], a[20:23], a[100:103], v[228:231]
v_mfma_f32_16x16x32_bf16 v[232:235], a[24:27], a[100:103], v[232:235]
buffer_load_dwordx4 v8, s[8:11], s40 offen lds
v_mfma_f32_16x16x32_bf16 v[236:239], a[28:31], a[100:103], v[236:239]
v_mfma_f32_16x16x32_bf16 v[240:243], a[88:91], a[32:35], v[240:243]
v_mfma_f32_16x16x32_bf16 v[244:247], a[92:95], a[32:35], v[244:247]
s_waitcnt vmcnt(15) lgkmcnt(0)
s_barrier
s_add_u32 s44, s47, s53
s_add_u32 s45, s44, 4096
s_add_u32 s46, s47, s54
s_add_u32 s50, s47, 34816
v_mfma_f32_16x16x32_bf16 v[48:51], a[108:111], a[40:43], v[48:51]
s_cmp_eq_u32 s50, 104448
s_cselect_b32 s50, 0, s50
v_mfma_f32_16x16x32_bf16 v[52:55], a[108:111], a[44:47], v[52:55]
s_sub_u32 s48, s50, s47
s_mov_b32 s47, s50
v_mfma_f32_16x16x32_bf16 v[56:59], a[108:111], a[48:51], v[56:59]
v_add_u32 v9, s48, v9
v_add_u32 v10, s48, v10
v_mfma_f32_16x16x32_bf16 v[60:63], a[108:111], a[52:55], v[60:63]
s_add_u32 s40, s40, 128
v_mfma_f32_16x16x32_bf16 v[64:67], a[108:111], a[56:59], v[64:67]
s_and_b32 s40, s40, 2047
s_add_u32 s41, s40, s52
ds_read_b64_tr_b16 a[80:81], v11 offset:24576
v_mfma_f32_16x16x32_bf16 v[68:71], a[108:111], a[60:63], v[68:71]
s_add_u32 s42, s41, 65536
v_mfma_f32_16x16x32_bf16 v[72:75], a[108:111], a[64:67], v[72:75]
ds_read_b128 a[0:3], v9 offset:0
v_mfma_f32_16x16x32_bf16 v[76:79], a[108:111], a[68:71], v[76:79]
v_mfma_f32_16x16x32_bf16 v[80:83], a[112:115], a[40:43], v[80:83]
ds_read_b64_tr_b16 a[82:83], v11 offset:25088
v_mfma_f32_16x16x32_bf16 v[84:87], a[112:115], a[44:47], v[84:87]
s_add_u32 s38, s38, 32
s_and_b32 s38, s38, 1023
s_mul_i32 s39, s38, 6144
s_mov_b32 m0, s35
v_mfma_f32_16x16x32_bf16 v[88:91], a[112:115], a[48:51], v[88:91]
ds_read_b128 a[4:7], v9 offset:2048
v_mfma_f32_16x16x32_bf16 v[92:95], a[112:115], a[52:55], v[92:95]
ds_read_b64_tr_b16 a[84:85], v12 offset:24576
v_mfma_f32_16x16x32_bf16 v[96:99], a[112:115], a[56:59], v[96:99]
v_mfma_f32_16x16x32_bf16 v[100:103], a[112:115], a[60:63], v[100:103]
ds_read_b128 a[8:11], v9 offset:4096
buffer_load_dwordx4 v5, s[12:15], s39 offen offset:0 lds
v_mfma_f32_16x16x32_bf16 v[104:107], a[112:115], a[64:67], v[104:107]
v_mfma_f32_16x16x32_bf16 v[108:111], a[112:115], a[68:71], v[108:111]
ds_read_b64_tr_b16 a[86:87], v12 offset:25088
v_mfma_f32_16x16x32_bf16 v[112:115], a[116:119], a[40:43], v[112:115]
v_mfma_f32_16x16x32_bf16 v[116:119], a[116:119], a[44:47], v[116:119]
ds_read_b64_tr_b16 a[88:89], v11 offset:25600
v_mfma_f32_16x16x32_bf16 v[120:123], a[116:119], a[48:51], v[120:123]
buffer_load_dwordx4 v6, s[12:15], s39 offen offset:1024 lds
ds_read_b128 a[12:15], v9 offset:6144
v_mfma_f32_16x16x32_bf16 v[124:127], a[116:119], a[52:55], v[124:127]
v_mfma_f32_16x16x32_bf16 v[128:131], a[116:119], a[56:59], v[128:131]
ds_read_b64_tr_b16 a[90:91], v11 offset:26112
v_mfma_f32_16x16x32_bf16 v[132:135], a[116:119], a[60:63], v[132:135]
v_mfma_f32_16x16x32_bf16 v[136:139], a[116:119], a[64:67], v[136:139]
ds_read_b128 a[16:19], v9 offset:8192
v_mfma_f32_16x16x32_bf16 v[140:143], a[116:119], a[68:71], v[140:143]
buffer_load_dwordx4 v7, s[12:15], s39 offen offset:2048 lds
v_mfma_f32_16x16x32_bf16 v[144:147], a[120:123], a[40:43], v[144:147]
ds_read_b64_tr_b16 a[92:93], v12 offset:25600
v_mfma_f32_16x16x32_bf16 v[148:151], a[120:123], a[44:47], v[148:151]
v_mfma_f32_16x16x32_bf16 v[152:155], a[120:123], a[48:51], v[152:155]
ds_read_b128 a[20:23], v9 offset:10240
v_mfma_f32_16x16x32_bf16 v[156:159], a[120:123], a[52:55], v[156:159]
s_mov_b32 m0, s44
ds_read_b64_tr_b16 a[94:95], v12 offset:26112
v_mfma_f32_16x16x32_bf16 v[160:163], a[120:123], a[56:59], v[160:163]
v_mfma_f32_16x16x32_bf16 v[164:167], a[120:123], a[60:63], v[164:167]
s_cmp_eq_u32 s33, s27
s_cbranch_scc0 L_noc3_qkv0
buffer_load_dword a202, v31, s[12:15], 0 offen
L_noc3_qkv0:
ds_read_b64_tr_b16 a[96:97], v11 offset:26624
v_mfma_f32_16x16x32_bf16 v[168:171], a[120:123], a[64:67], v[168:171]
v_mfma_f32_16x16x32_bf16 v[172:175], a[120:123], a[68:71], v[172:175]
ds_read_b128 a[24:27], v9 offset:12288
v_mfma_f32_16x16x32_bf16 v[176:179], a[40:43], a[124:127], v[176:179]
buffer_load_dwordx4 v1, s[8:11], s41 offen offset:0 lds
v_mfma_f32_16x16x32_bf16 v[180:183], a[44:47], a[124:127], v[180:183]
ds_read_b64_tr_b16 a[98:99], v11 offset:27136
v_mfma_f32_16x16x32_bf16 v[184:187], a[48:51], a[124:127], v[184:187]
ds_read_b128 a[28:31], v9 offset:14336
v_mfma_f32_16x16x32_bf16 v[188:191], a[52:55], a[124:127], v[188:191]
v_mfma_f32_16x16x32_bf16 v[192:195], a[56:59], a[124:127], v[192:195]
ds_read_b64_tr_b16 a[100:101], v12 offset:26624
buffer_load_dwordx4 v2, s[8:11], s41 offen offset:1024 lds
v_mfma_f32_16x16x32_bf16 v[196:199], a[60:63], a[124:127], v[196:199]
v_mfma_f32_16x16x32_bf16 v[200:203], a[64:67], a[124:127], v[200:203]
ds_read_b128 a[32:35], v9 offset:32768
v_mfma_f32_16x16x32_bf16 v[204:207], a[68:71], a[124:127], v[204:207]
v_mfma_f32_16x16x32_bf16 v[208:211], a[40:43], a[128:131], v[208:211]
ds_read_b64_tr_b16 a[102:103], v12 offset:27136
v_mfma_f32_16x16x32_bf16 v[212:215], a[44:47], a[128:131], v[212:215]
buffer_load_dwordx4 v3, s[8:11], s41 offen offset:2048 lds
v_mfma_f32_16x16x32_bf16 v[216:219], a[48:51], a[128:131], v[216:219]
v_mfma_f32_16x16x32_bf16 v[220:223], a[52:55], a[128:131], v[220:223]
v_mfma_f32_16x16x32_bf16 v[224:227], a[56:59], a[128:131], v[224:227]
v_mfma_f32_16x16x32_bf16 v[228:231], a[60:63], a[128:131], v[228:231]
v_mfma_f32_16x16x32_bf16 v[232:235], a[64:67], a[128:131], v[232:235]
buffer_load_dwordx4 v4, s[8:11], s41 offen offset:3072 lds
v_mfma_f32_16x16x32_bf16 v[236:239], a[68:71], a[128:131], v[236:239]
v_mfma_f32_16x16x32_bf16 v[240:243], a[116:119], a[72:75], v[240:243]
v_mfma_f32_16x16x32_bf16 v[244:247], a[120:123], a[72:75], v[244:247]
s_waitcnt vmcnt(15) lgkmcnt(0)
s_barrier
v_mfma_f32_16x16x32_bf16 v[48:51], a[80:83], a[0:3], v[48:51]
ds_read_b64_tr_b16 a[108:109], v11 offset:36864
v_mfma_f32_16x16x32_bf16 v[52:55], a[80:83], a[4:7], v[52:55]
v_mfma_f32_16x16x32_bf16 v[56:59], a[80:83], a[8:11], v[56:59]
ds_read_b128 a[40:43], v10 offset:0
v_mfma_f32_16x16x32_bf16 v[60:63], a[80:83], a[12:15], v[60:63]
v_mfma_f32_16x16x32_bf16 v[64:67], a[80:83], a[16:19], v[64:67]
ds_read_b64_tr_b16 a[110:111], v11 offset:37376
v_mfma_f32_16x16x32_bf16 v[68:71], a[80:83], a[20:23], v[68:71]
v_mfma_f32_16x16x32_bf16 v[72:75], a[80:83], a[24:27], v[72:75]
ds_read_b128 a[44:47], v10 offset:2048
v_mfma_f32_16x16x32_bf16 v[76:79], a[80:83], a[28:31], v[76:79]
v_mfma_f32_16x16x32_bf16 v[80:83], a[84:87], a[0:3], v[80:83]
ds_read_b64_tr_b16 a[112:113], v12 offset:36864
s_add_u32 s38, s38, 32
s_and_b32 s38, s38, 1023
s_mul_i32 s39, s38, 6144
s_mov_b32 m0, s36
v_mfma_f32_16x16x32_bf16 v[84:87], a[84:87], a[4:7], v[84:87]
v_mfma_f32_16x16x32_bf16 v[88:91], a[84:87], a[8:11], v[88:91]
ds_read_b128 a[48:51], v10 offset:4096
v_mfma_f32_16x16x32_bf16 v[92:95], a[84:87], a[12:15], v[92:95]
v_mfma_f32_16x16x32_bf16 v[96:99], a[84:87], a[16:19], v[96:99]
buffer_load_dwordx4 v5, s[12:15], s39 offen offset:0 lds
ds_read_b64_tr_b16 a[114:115], v12 offset:37376
v_mfma_f32_16x16x32_bf16 v[100:103], a[84:87], a[20:23], v[100:103]
v_mfma_f32_16x16x32_bf16 v[104:107], a[84:87], a[24:27], v[104:107]
ds_read_b64_tr_b16 a[116:117], v11 offset:37888
v_mfma_f32_16x16x32_bf16 v[108:111], a[84:87], a[28:31], v[108:111]
s_cmp_eq_u32 s33, s24
s_cbranch_scc0 L_noinit_qkv0
s_mov_b64 exec, 1
buffer_atomic_add v17, v18, s[4:7], 0 offen sc1
s_mov_b64 exec, -1
L_noinit_qkv0:
v_mfma_f32_16x16x32_bf16 v[112:115], a[88:91], a[0:3], v[112:115]
buffer_load_dwordx4 v6, s[12:15], s39 offen offset:1024 lds
ds_read_b128 a[52:55], v10 offset:6144
v_mfma_f32_16x16x32_bf16 v[116:119], a[88:91], a[4:7], v[116:119]
v_mfma_f32_16x16x32_bf16 v[120:123], a[88:91], a[8:11], v[120:123]
ds_read_b64_tr_b16 a[118:119], v11 offset:38400
v_mfma_f32_16x16x32_bf16 v[124:127], a[88:91], a[12:15], v[124:127]
v_mfma_f32_16x16x32_bf16 v[128:131], a[88:91], a[16:19], v[128:131]
buffer_load_dwordx4 v7, s[12:15], s39 offen offset:2048 lds
ds_read_b128 a[56:59], v10 offset:8192
v_mfma_f32_16x16x32_bf16 v[132:135], a[88:91], a[20:23], v[132:135]
v_mfma_f32_16x16x32_bf16 v[136:139], a[88:91], a[24:27], v[136:139]
ds_read_b64_tr_b16 a[120:121], v12 offset:37888
v_mfma_f32_16x16x32_bf16 v[140:143], a[88:91], a[28:31], v[140:143]
s_mov_b32 m0, s45
v_mfma_f32_16x16x32_bf16 v[144:147], a[92:95], a[0:3], v[144:147]
ds_read_b128 a[60:63], v10 offset:10240
v_mfma_f32_16x16x32_bf16 v[148:151], a[92:95], a[4:7], v[148:151]
v_mfma_f32_16x16x32_bf16 v[152:155], a[92:95], a[8:11], v[152:155]
ds_read_b64_tr_b16 a[122:123], v12 offset:38400
v_mfma_f32_16x16x32_bf16 v[156:159], a[92:95], a[12:15], v[156:159]
buffer_load_dwordx4 v1, s[8:11], s42 offen offset:0 lds
v_mfma_f32_16x16x32_bf16 v[160:163], a[92:95], a[16:19], v[160:163]
ds_read_b64_tr_b16 a[124:125], v11 offset:38912
v_mfma_f32_16x16x32_bf16 v[164:167], a[92:95], a[20:23], v[164:167]
v_mfma_f32_16x16x32_bf16 v[168:171], a[92:95], a[24:27], v[168:171]
ds_read_b128 a[64:67], v10 offset:12288
v_mfma_f32_16x16x32_bf16 v[172:175], a[92:95], a[28:31], v[172:175]
buffer_load_dwordx4 v2, s[8:11], s42 offen offset:1024 lds
v_mfma_f32_16x16x32_bf16 v[176:179], a[0:3], a[96:99], v[176:179]
ds_read_b64_tr_b16 a[126:127], v11 offset:39424
v_mfma_f32_16x16x32_bf16 v[180:183], a[4:7], a[96:99], v[180:183]
v_mfma_f32_16x16x32_bf16 v[184:187], a[8:11], a[96:99], v[184:187]
ds_read_b128 a[68:71], v10 offset:14336
v_mfma_f32_16x16x32_bf16 v[188:191], a[12:15], a[96:99], v[188:191]
buffer_load_dwordx4 v3, s[8:11], s42 offen offset:2048 lds
v_mfma_f32_16x16x32_bf16 v[192:195], a[16:19], a[96:99], v[192:195]
ds_read_b64_tr_b16 a[128:129], v12 offset:38912
v_mfma_f32_16x16x32_bf16 v[196:199], a[20:23], a[96:99], v[196:199]
v_mfma_f32_16x16x32_bf16 v[200:203], a[24:27], a[96:99], v[200:203]
ds_read_b128 a[72:75], v10 offset:32768
v_mfma_f32_16x16x32_bf16 v[204:207], a[28:31], a[96:99], v[204:207]
buffer_load_dwordx4 v4, s[8:11], s42 offen offset:3072 lds
v_mfma_f32_16x16x32_bf16 v[208:211], a[0:3], a[100:103], v[208:211]
ds_read_b64_tr_b16 a[130:131], v12 offset:39424
v_mfma_f32_16x16x32_bf16 v[212:215], a[4:7], a[100:103], v[212:215]
v_mfma_f32_16x16x32_bf16 v[216:219], a[8:11], a[100:103], v[216:219]
s_mov_b32 m0, s46
v_mfma_f32_16x16x32_bf16 v[220:223], a[12:15], a[100:103], v[220:223]
v_mfma_f32_16x16x32_bf16 v[224:227], a[16:19], a[100:103], v[224:227]
v_mfma_f32_16x16x32_bf16 v[228:231], a[20:23], a[100:103], v[228:231]
v_mfma_f32_16x16x32_bf16 v[232:235], a[24:27], a[100:103], v[232:235]
buffer_load_dwordx4 v8, s[8:11], s40 offen lds
v_mfma_f32_16x16x32_bf16 v[236:239], a[28:31], a[100:103], v[236:239]
v_mfma_f32_16x16x32_bf16 v[240:243], a[88:91], a[32:35], v[240:243]
v_mfma_f32_16x16x32_bf16 v[244:247], a[92:95], a[32:35], v[244:247]
s_waitcnt vmcnt(15) lgkmcnt(0)
s_barrier
s_add_u32 s44, s47, s53
s_add_u32 s45, s44, 4096
s_add_u32 s46, s47, s54
s_add_u32 s50, s47, 34816
v_mfma_f32_16x16x32_bf16 v[48:51], a[108:111], a[40:43], v[48:51]
s_cmp_eq_u32 s50, 104448
s_cselect_b32 s50, 0, s50
v_mfma_f32_16x16x32_bf16 v[52:55], a[108:111], a[44:47], v[52:55]
s_sub_u32 s48, s50, s47
s_mov_b32 s47, s50
v_mfma_f32_16x16x32_bf16 v[56:59], a[108:111], a[48:51], v[56:59]
v_add_u32 v9, s48, v9
v_add_u32 v10, s48, v10
v_mfma_f32_16x16x32_bf16 v[60:63], a[108:111], a[52:55], v[60:63]
s_add_u32 s40, s40, 128
v_mfma_f32_16x16x32_bf16 v[64:67], a[108:111], a[56:59], v[64:67]
s_and_b32 s40, s40, 2047
s_add_u32 s41, s40, s52
ds_read_b64_tr_b16 a[80:81], v11 offset:0
v_mfma_f32_16x16x32_bf16 v[68:71], a[108:111], a[60:63], v[68:71]
s_add_u32 s42, s41, 65536
v_mfma_f32_16x16x32_bf16 v[72:75], a[108:111], a[64:67], v[72:75]
ds_read_b128 a[0:3], v9 offset:0
v_mfma_f32_16x16x32_bf16 v[76:79], a[108:111], a[68:71], v[76:79]
v_mfma_f32_16x16x32_bf16 v[80:83], a[112:115], a[40:43], v[80:83]
ds_read_b64_tr_b16 a[82:83], v11 offset:512
v_mfma_f32_16x16x32_bf16 v[84:87], a[112:115], a[44:47], v[84:87]
s_add_u32 s38, s38, 32
s_and_b32 s38, s38, 1023
s_mul_i32 s39, s38, 6144
s_mov_b32 m0, s37
v_mfma_f32_16x16x32_bf16 v[88:91], a[112:115], a[48:51], v[88:91]
ds_read_b128 a[4:7], v9 offset:2048
v_mfma_f32_16x16x32_bf16 v[92:95], a[112:115], a[52:55], v[92:95]
ds_read_b64_tr_b16 a[84:85], v12 offset:0
v_mfma_f32_16x16x32_bf16 v[96:99], a[112:115], a[56:59], v[96:99]
v_mfma_f32_16x16x32_bf16 v[100:103], a[112:115], a[60:63], v[100:103]
ds_read_b128 a[8:11], v9 offset:4096
buffer_load_dwordx4 v5, s[12:15], s39 offen offset:0 lds
v_mfma_f32_16x16x32_bf16 v[104:107], a[112:115], a[64:67], v[104:107]
v_mfma_f32_16x16x32_bf16 v[108:111], a[112:115], a[68:71], v[108:111]
ds_read_b64_tr_b16 a[86:87], v12 offset:512
v_mfma_f32_16x16x32_bf16 v[112:115], a[116:119], a[40:43], v[112:115]
v_mfma_f32_16x16x32_bf16 v[116:119], a[116:119], a[44:47], v[116:119]
ds_read_b64_tr_b16 a[88:89], v11 offset:1024
v_mfma_f32_16x16x32_bf16 v[120:123], a[116:119], a[48:51], v[120:123]
buffer_load_dwordx4 v6, s[12:15], s39 offen offset:1024 lds
ds_read_b128 a[12:15], v9 offset:6144
v_mfma_f32_16x16x32_bf16 v[124:127], a[116:119], a[52:55], v[124:127]
v_mfma_f32_16x16x32_bf16 v[128:131], a[116:119], a[56:59], v[128:131]
ds_read_b64_tr_b16 a[90:91], v11 offset:1536
v_mfma_f32_16x16x32_bf16 v[132:135], a[116:119], a[60:63], v[132:135]
v_mfma_f32_16x16x32_bf16 v[136:139], a[116:119], a[64:67], v[136:139]
ds_read_b128 a[16:19], v9 offset:8192
v_mfma_f32_16x16x32_bf16 v[140:143], a[116:119], a[68:71], v[140:143]
buffer_load_dwordx4 v7, s[12:15], s39 offen offset:2048 lds
v_mfma_f32_16x16x32_bf16 v[144:147], a[120:123], a[40:43], v[144:147]
ds_read_b64_tr_b16 a[92:93], v12 offset:1024
v_mfma_f32_16x16x32_bf16 v[148:151], a[120:123], a[44:47], v[148:151]
v_mfma_f32_16x16x32_bf16 v[152:155], a[120:123], a[48:51], v[152:155]
ds_read_b128 a[20:23], v9 offset:10240
v_mfma_f32_16x16x32_bf16 v[156:159], a[120:123], a[52:55], v[156:159]
s_mov_b32 m0, s44
ds_read_b64_tr_b16 a[94:95], v12 offset:1536
v_mfma_f32_16x16x32_bf16 v[160:163], a[120:123], a[56:59], v[160:163]
v_mfma_f32_16x16x32_bf16 v[164:167], a[120:123], a[60:63], v[164:167]
ds_read_b64_tr_b16 a[96:97], v11 offset:2048
v_mfma_f32_16x16x32_bf16 v[168:171], a[120:123], a[64:67], v[168:171]
v_mfma_f32_16x16x32_bf16 v[172:175], a[120:123], a[68:71], v[172:175]
ds_read_b128 a[24:27], v9 offset:12288
v_mfma_f32_16x16x32_bf16 v[176:179], a[40:43], a[124:127], v[176:179]
buffer_load_dwordx4 v1, s[8:11], s41 offen offset:0 lds
v_mfma_f32_16x16x32_bf16 v[180:183], a[44:47], a[124:127], v[180:183]
ds_read_b64_tr_b16 a[98:99], v11 offset:2560
v_mfma_f32_16x16x32_bf16 v[184:187], a[48:51], a[124:127], v[184:187]
ds_read_b128 a[28:31], v9 offset:14336
v_mfma_f32_16x16x32_bf16 v[188:191], a[52:55], a[124:127], v[188:191]
v_mfma_f32_16x16x32_bf16 v[192:195], a[56:59], a[124:127], v[192:195]
ds_read_b64_tr_b16 a[100:101], v12 offset:2048
buffer_load_dwordx4 v2, s[8:11], s41 offen offset:1024 lds
v_mfma_f32_16x16x32_bf16 v[196:199], a[60:63], a[124:127], v[196:199]
v_mfma_f32_16x16x32_bf16 v[200:203], a[64:67], a[124:127], v[200:203]
ds_read_b128 a[32:35], v9 offset:32768
v_mfma_f32_16x16x32_bf16 v[204:207], a[68:71], a[124:127], v[204:207]
v_mfma_f32_16x16x32_bf16 v[208:211], a[40:43], a[128:131], v[208:211]
ds_read_b64_tr_b16 a[102:103], v12 offset:2560
v_mfma_f32_16x16x32_bf16 v[212:215], a[44:47], a[128:131], v[212:215]
buffer_load_dwordx4 v3, s[8:11], s41 offen offset:2048 lds
v_mfma_f32_16x16x32_bf16 v[216:219], a[48:51], a[128:131], v[216:219]
v_mfma_f32_16x16x32_bf16 v[220:223], a[52:55], a[128:131], v[220:223]
v_mfma_f32_16x16x32_bf16 v[224:227], a[56:59], a[128:131], v[224:227]
v_mfma_f32_16x16x32_bf16 v[228:231], a[60:63], a[128:131], v[228:231]
v_mfma_f32_16x16x32_bf16 v[232:235], a[64:67], a[128:131], v[232:235]
buffer_load_dwordx4 v4, s[8:11], s41 offen offset:3072 lds
v_mfma_f32_16x16x32_bf16 v[236:239], a[68:71], a[128:131], v[236:239]
v_mfma_f32_16x16x32_bf16 v[240:243], a[116:119], a[72:75], v[240:243]
v_mfma_f32_16x16x32_bf16 v[244:247], a[120:123], a[72:75], v[244:247]
s_waitcnt vmcnt(15) lgkmcnt(0)
s_barrier
s_add_u32 s33, s33, 1
s_cmp_lt_u32 s33, 8
s_cbranch_scc1 L_loop_qkv0
s_waitcnt vmcnt(0)
s_barrier
v_cvt_pk_bf16_f32 v124, v124, v125
v_cvt_pk_bf16_f32 v120, v120, v121
v_cvt_pk_bf16_f32 v116, v116, v117
v_cvt_pk_bf16_f32 v112, v112, v113
v_cvt_pk_bf16_f32 v56, v56, v57
v_cvt_pk_bf16_f32 v60, v60, v61
v_cvt_pk_bf16_f32 v125, v126, v127
v_cvt_pk_bf16_f32 v121, v122, v123
v_cvt_pk_bf16_f32 v117, v118, v119
v_cvt_pk_bf16_f32 v113, v114, v115
v_cvt_pk_bf16_f32 v57, v58, v59
v_cvt_pk_bf16_f32 v61, v62, v63
v_cvt_pk_bf16_f32 v126, v156, v157
v_cvt_pk_bf16_f32 v127, v158, v159
v_cvt_pk_bf16_f32 v122, v152, v153
v_cvt_pk_bf16_f32 v123, v154, v155
v_cvt_pk_bf16_f32 v118, v148, v149
v_cvt_pk_bf16_f32 v119, v150, v151
v_cvt_pk_bf16_f32 v114, v144, v145
v_cvt_pk_bf16_f32 v115, v146, v147
v_cvt_pk_bf16_f32 v58, v88, v89
v_cvt_pk_bf16_f32 v59, v90, v91
v_cvt_pk_bf16_f32 v62, v92, v93
v_cvt_pk_bf16_f32 v63, v94, v95
v_cvt_pk_bf16_f32 v64, v64, v65
v_cvt_pk_bf16_f32 v68, v68, v69
v_cvt_pk_bf16_f32 v48, v48, v49
v_cvt_pk_bf16_f32 v52, v52, v53
v_cvt_pk_bf16_f32 v65, v66, v67
v_cvt_pk_bf16_f32 v69, v70, v71
v_cvt_pk_bf16_f32 v49, v50, v51
v_cvt_pk_bf16_f32 v53, v54, v55
v_cvt_pk_bf16_f32 v66, v96, v97
v_cvt_pk_bf16_f32 v67, v98, v99
v_cvt_pk_bf16_f32 v70, v100, v101
v_cvt_pk_bf16_f32 v50, v80, v81
v_cvt_pk_bf16_f32 v51, v82, v83
v_cvt_pk_bf16_f32 v54, v84, v85
v_cvt_pk_bf16_f32 v55, v86, v87
v_mfma_f32_16x16x32_bf16 v[80:83], v[112:115], v[56:59], 0
v_mfma_f32_16x16x32_bf16 v[84:87], v[120:123], v[56:59], 0
v_mfma_f32_16x16x32_bf16 v[94:97], v[116:119], v[60:63], 0
v_mfma_f32_16x16x32_bf16 v[98:101], v[124:127], v[60:63], 0
v_cvt_pk_bf16_f32 v72, v72, v73
v_cvt_pk_bf16_f32 v73, v74, v75
v_cvt_pk_bf16_f32 v75, v106, v107
s_lshl_b32 s50, s31, 1
s_add_u32 s50, s50, 0
s_mul_i32 s50, s50, 1474560
v_cndmask_b32 v84, v84, v80, s[56:57]
v_cndmask_b32 v85, v85, v81, s[58:59]
v_cndmask_b32 v86, v86, v82, s[60:61]
v_cndmask_b32 v87, v87, v83, s[62:63]
v_cndmask_b32 v98, v98, v94, s[56:57]
v_cndmask_b32 v99, v99, v95, s[58:59]
v_cndmask_b32 v100, v100, v96, s[60:61]
v_cndmask_b32 v101, v101, v97, s[62:63]
v_pk_fma_f32 v[84:85], v[84:85], s[68:69], v[32:33]
v_pk_fma_f32 v[86:87], v[86:87], s[68:69], v[34:35]
v_pk_fma_f32 v[98:99], v[98:99], s[68:69], v[32:33]
v_pk_fma_f32 v[100:101], v[100:101], s[68:69], v[34:35]
v_max3_f32 v92, v84, v85, v86
v_max3_f32 v106, v98, v99, v100
v_max_f32 v92, v92, v87
v_max_f32 v106, v106, v101
s_lshl_b32 s51, s32, 1
s_add_u32 s51, s51, s30
v_permlane16_swap_b32 v92, v106
v_max_f32 v92, v92, v106
v_mov_b32 v93, v92
s_mul_i32 s51, s51, 10240
s_add_u32 s65, s50, s51
v_permlane32_swap_b32 v93, v92
v_max_f32 v92, v93, v92
v_mov_b32 v93, v92
s_add_u32 s66, s65, 5120
s_lshl_b32 s70, s31, 8
v_permlane16_swap_b32 v93, v92
v_pk_add_f32 v[84:85], v[84:85], v[92:93] op_sel:[0,1] op_sel_hi:[1,1] neg_lo:[0,1] neg_hi:[0,1]
v_pk_add_f32 v[86:87], v[86:87], v[92:93] op_sel:[0,1] op_sel_hi:[1,1] neg_lo:[0,1] neg_hi:[0,1]
v_pk_add_f32 v[98:99], v[98:99], v[92:93] op_sel:[0,0] op_sel_hi:[1,0] neg_lo:[0,1] neg_hi:[0,1]
v_pk_add_f32 v[100:101], v[100:101], v[92:93] op_sel:[0,0] op_sel_hi:[1,0] neg_lo:[0,1] neg_hi:[0,1]
s_lshl_b32 s51, s32, 4
v_cvt_pk_bf16_f32 v76, v76, v77
v_exp_f32 v84, v84
v_exp_f32 v85, v85
v_exp_f32 v86, v86
v_exp_f32 v87, v87
v_exp_f32 v98, v98
v_exp_f32 v99, v99
v_exp_f32 v100, v100
v_exp_f32 v101, v101
s_add_u32 s70, s70, s51
v_cvt_pk_bf16_f32 v74, v104, v105
v_cvt_pk_bf16_f32 v77, v78, v79
s_lshl_b32 s51, s28, 2
v_cvt_pk_bf16_f32 v71, v102, v103
v_cvt_pk_bf16_f32 v78, v108, v109
v_cvt_pk_bf16_f32 v90, v84, v85
v_cvt_pk_bf16_f32 v91, v86, v87
v_cvt_pk_bf16_f32 v104, v98, v99
v_cvt_pk_bf16_f32 v105, v100, v101
s_add_u32 s70, s70, s51
v_cvt_pk_bf16_f32 v79, v110, v111
v_lshrrev_b32 v108, 4, v0
v_and_b32 v88, v90, v40
v_and_b32 v89, v91, v41
v_and_b32 v102, v104, v40
v_and_b32 v103, v105, v41
v_cvt_pk_bf16_f32 v136, v136, v137
v_cvt_pk_bf16_f32 v132, v132, v133
v_add_u32 v108, s70, v108
v_and_b32 v110, 15, v0
v_and_b32 v90, v90, v42
v_and_b32 v91, v91, v43
v_and_b32 v104, v104, v42
v_and_b32 v105, v105, v43
s_lshl_b32 s71, s30, 13
v_cvt_pk_bf16_f32 v137, v138, v139
v_cvt_pk_bf16_f32 v133, v134, v135
v_lshlrev_b32 v109, 11, v108
v_lshlrev_b32 v110, 4, v110
s_mov_b32 s10, 0x400000
v_cvt_pk_bf16_f32 v138, v168, v169
v_cvt_pk_bf16_f32 v135, v166, v167
v_cvt_pk_bf16_f32 v146, v176, v177
v_cvt_pk_bf16_f32 v147, v178, v179
v_cvt_pk_bf16_f32 v156, v180, v181
v_cvt_pk_bf16_f32 v157, v182, v183
v_cvt_pk_bf16_f32 v148, v184, v185
v_cvt_pk_bf16_f32 v149, v186, v187
v_cvt_pk_bf16_f32 v158, v188, v189
v_cvt_pk_bf16_f32 v159, v190, v191
v_add_u32 v109, v109, v110
v_cvt_pk_bf16_f32 v166, v208, v209
v_cvt_pk_bf16_f32 v167, v210, v211
v_cvt_pk_bf16_f32 v4, v212, v213
v_cvt_pk_bf16_f32 v5, v214, v215
v_cvt_pk_bf16_f32 v168, v216, v217
v_cvt_pk_bf16_f32 v169, v218, v219
v_cvt_pk_bf16_f32 v6, v220, v221
v_cvt_pk_bf16_f32 v7, v222, v223
buffer_load_dwordx4 v[176:179], v109, s[8:11], 0 offen offset:0
v_mfma_f32_16x16x32_bf16 v[84:87], v[44:47], v[88:91], 0
v_mfma_f32_16x16x32_bf16 v[98:101], v[44:47], v[102:105], 0
v_cvt_pk_bf16_f32 v128, v128, v129
buffer_load_dwordx4 v[180:183], v109, s[8:11], 0 offen offset:256
v_cvt_pk_bf16_f32 v129, v130, v131
buffer_load_dwordx4 v[184:187], v109, s[8:11], 0 offen offset:512
v_mfma_f32_16x16x32_bf16 v[56:59], v[146:149], v[88:91], 0
v_mfma_f32_16x16x32_bf16 v[60:63], v[156:159], v[102:105], 0
v_cvt_pk_bf16_f32 v130, v160, v161
v_cvt_pk_bf16_f32 v150, v192, v193
v_cvt_pk_bf16_f32 v151, v194, v195
buffer_load_dwordx4 v[188:191], v109, s[8:11], 0 offen offset:768
v_mfma_f32_16x16x32_bf16 v[80:83], v[166:169], v[88:91], 0
v_mfma_f32_16x16x32_bf16 v[94:97], v[4:7], v[102:105], 0
v_cvt_pk_bf16_f32 v160, v196, v197
v_cvt_pk_bf16_f32 v161, v198, v199
buffer_load_dwordx4 v[192:195], v109, s[8:11], 0 offen offset:1024
v_cvt_pk_bf16_f32 v131, v162, v163
v_cvt_pk_bf16_f32 v152, v200, v201
v_cvt_pk_bf16_f32 v153, v202, v203
buffer_load_dwordx4 v[196:199], v109, s[8:11], 0 offen offset:1280
v_cvt_pk_bf16_f32 v162, v204, v205
v_cvt_pk_bf16_f32 v163, v206, v207
buffer_load_dwordx4 v[200:203], v109, s[8:11], 0 offen offset:1536
buffer_load_dwordx4 v[204:207], v109, s[8:11], 0 offen offset:1792
v_cvt_pk_bf16_f32 v140, v140, v141
buffer_load_dwordx4 v[208:211], v110, s[20:23], 0 offen offset:0
v_cvt_pk_bf16_f32 v141, v142, v143
buffer_load_dwordx4 v[212:215], v110, s[20:23], 0 offen offset:256
v_rcp_f32 v84, v84
v_rcp_f32 v98, v98
v_lshlrev_b32 v1, 4, v0
v_cvt_pk_bf16_f32 v143, v174, v175
v_cvt_pk_bf16_f32 v139, v170, v171
buffer_load_dwordx4 v[216:219], v110, s[20:23], 0 offen offset:512
v_add_u32 v174, s71, v1
v_cvt_pk_bf16_f32 v170, v224, v225
v_cvt_pk_bf16_f32 v171, v226, v227
buffer_load_dwordx4 v[220:223], v110, s[20:23], 0 offen offset:768
v_pk_mul_f32 v[56:57], v[56:57], v[84:85] op_sel_hi:[1,0]
v_pk_mul_f32 v[58:59], v[58:59], v[84:85] op_sel_hi:[1,0]
v_pk_mul_f32 v[60:61], v[60:61], v[98:99] op_sel_hi:[1,0]
v_pk_mul_f32 v[62:63], v[62:63], v[98:99] op_sel_hi:[1,0]
v_cvt_pk_bf16_f32 v142, v172, v173
v_lshlrev_b32 v175, 3, v0
v_cvt_pk_bf16_f32 v8, v228, v229
v_cvt_pk_bf16_f32 v9, v230, v231
v_cvt_pk_bf16_f32 v240, v240, v241
ds_write_b128 v174, v[136:139] offset:0
buffer_load_dwordx4 v[224:227], v110, s[20:23], 0 offen offset:1024
v_pk_mul_f32 v[80:81], v[80:81], v[84:85] op_sel_hi:[1,0]
v_pk_mul_f32 v[82:83], v[82:83], v[84:85] op_sel_hi:[1,0]
v_pk_mul_f32 v[94:95], v[94:95], v[98:99] op_sel_hi:[1,0]
v_pk_mul_f32 v[96:97], v[96:97], v[98:99] op_sel_hi:[1,0]
v_lshrrev_b32 v1, 3, v0
v_cvt_pk_bf16_f32 v88, v56, v57
v_cvt_pk_bf16_f32 v89, v58, v59
v_cvt_pk_bf16_f32 v90, v60, v61
v_cvt_pk_bf16_f32 v91, v62, v63
v_add_u32 v175, s71, v175
v_cvt_pk_bf16_f32 v172, v232, v233
v_cvt_pk_bf16_f32 v173, v234, v235
v_cvt_pk_bf16_f32 v241, v242, v243
ds_write_b128 v174, v[140:143] offset:1024
buffer_load_dwordx4 v[228:231], v110, s[20:23], 0 offen offset:1280
v_lshlrev_b32 v1, 2, v1
s_mov_b32 s50, 572662289
v_cvt_pk_bf16_f32 v102, v80, v81
v_cvt_pk_bf16_f32 v103, v82, v83
v_cvt_pk_bf16_f32 v104, v94, v95
v_cvt_pk_bf16_f32 v105, v96, v97
v_cvt_pk_bf16_f32 v10, v236, v237
v_cvt_pk_bf16_f32 v11, v238, v239
v_cvt_pk_bf16_f32 v242, v244, v245
v_cvt_pk_bf16_f32 v243, v246, v247
ds_write_b64 v175, v[152:153] offset:2048
v_lshlrev_b32 v111, 4, v0
buffer_load_dwordx4 v[232:235], v110, s[20:23], 0 offen offset:1536
v_lshrrev_b32 v109, 4, v108
v_bfe_u32 v1, s50, v1, 4
ds_write_b64 v175, v[162:163] offset:2560
buffer_load_dwordx4 v[236:239], v110, s[20:23], 0 offen offset:1792
v_and_b32 v108, 15, v108
v_lshl_add_u32 v1, v1, 7, v111
v_permlane16_swap_b32 v88, v90
v_permlane16_swap_b32 v89, v91
ds_write_b64 v175, v[172:173] offset:3072
v_lshlrev_b32 v109, 7, v109
v_lshlrev_b32 v108, 2, v108
buffer_store_dwordx4 v[88:91], v1, s[16:19], s65 offen offset:1024 sc1
v_permlane16_swap_b32 v102, v104
v_permlane16_swap_b32 v103, v105
v_cvt_pk_bf16_f32 v134, v164, v165
v_mov_b32_dpp v244, v240 row_ror:8 row_mask:0xf bank_mask:0xf
v_mov_b32_dpp v245, v241 row_ror:8 row_mask:0xf bank_mask:0xf
v_mov_b32_dpp v246, v242 row_ror:8 row_mask:0xf bank_mask:0xf
v_mov_b32_dpp v247, v243 row_ror:8 row_mask:0xf bank_mask:0xf
ds_write_b64 v175, v[10:11] offset:3584
v_add_u32 v108, v108, v109
buffer_store_dwordx4 v[102:105], v1, s[16:19], s66 offen offset:1024 sc1
s_waitcnt lgkmcnt(0)
s_barrier
v_mfma_f32_16x16x32_bf16 v[12:15], v[120:123], v[64:67], 0
v_mfma_f32_16x16x32_bf16 v[16:19], v[128:131], v[64:67], 0
v_mfma_f32_16x16x32_bf16 v[248:251], v[124:127], v[68:71], 0
v_mfma_f32_16x16x32_bf16 v[252:255], v[132:135], v[68:71], 0
v_mfma_f32_16x16x32_bf16 v[80:83], v[128:131], v[72:75], 0
v_mfma_f32_16x16x32_bf16 v[84:87], v[136:139], v[72:75], 0
v_mfma_f32_16x16x32_bf16 v[94:97], v[132:135], v[76:79], 0
v_mfma_f32_16x16x32_bf16 v[98:101], v[140:143], v[76:79], 0
v_lshrrev_b32 v1, 3, v0
v_lshlrev_b32 v1, 2, v1
v_cndmask_b32 v16, v16, v12, s[56:57]
v_cndmask_b32 v17, v17, v13, s[58:59]
v_cndmask_b32 v18, v18, v14, s[60:61]
v_cndmask_b32 v19, v19, v15, s[62:63]
v_cndmask_b32 v252, v252, v248, s[56:57]
v_cndmask_b32 v253, v253, v249, s[58:59]
v_cndmask_b32 v254, v254, v250, s[60:61]
v_cndmask_b32 v255, v255, v251, s[62:63]
v_pk_fma_f32 v[16:17], v[16:17], s[68:69], v[32:33]
v_pk_fma_f32 v[18:19], v[18:19], s[68:69], v[34:35]
v_pk_fma_f32 v[252:253], v[252:253], s[68:69], v[32:33]
v_pk_fma_f32 v[254:255], v[254:255], s[68:69], v[34:35]
v_max3_f32 v24, v16, v17, v18
v_max3_f32 v30, v252, v253, v254
v_max_f32 v24, v24, v19
v_max_f32 v30, v30, v255
v_cndmask_b32 v84, v84, v80, s[56:57]
v_cndmask_b32 v85, v85, v81, s[58:59]
v_permlane16_swap_b32 v24, v30
v_cndmask_b32 v86, v86, v82, s[60:61]
v_cndmask_b32 v87, v87, v83, s[62:63]
v_cndmask_b32 v98, v98, v94, s[56:57]
v_cndmask_b32 v99, v99, v95, s[58:59]
v_cndmask_b32 v100, v100, v96, s[60:61]
v_cndmask_b32 v101, v101, v97, s[62:63]
v_max_f32 v24, v24, v30
v_pk_fma_f32 v[84:85], v[84:85], s[68:69], v[32:33]
v_pk_fma_f32 v[86:87], v[86:87], s[68:69], v[34:35]
v_pk_fma_f32 v[98:99], v[98:99], s[68:69], v[32:33]
v_pk_fma_f32 v[100:101], v[100:101], s[68:69], v[34:35]
v_mov_b32 v25, v24
v_max3_f32 v92, v84, v85, v86
v_max3_f32 v106, v98, v99, v100
v_max_f32 v92, v92, v87
v_max_f32 v106, v106, v101
v_permlane32_swap_b32 v25, v24
v_max_f32 v24, v25, v24
v_permlane16_swap_b32 v92, v106
v_mov_b32 v25, v24
v_max_f32 v92, v92, v106
v_mov_b32 v93, v92
v_permlane16_swap_b32 v25, v24
v_pk_add_f32 v[16:17], v[16:17], v[24:25] op_sel:[0,1] op_sel_hi:[1,1] neg_lo:[0,1] neg_hi:[0,1]
v_pk_add_f32 v[18:19], v[18:19], v[24:25] op_sel:[0,1] op_sel_hi:[1,1] neg_lo:[0,1] neg_hi:[0,1]
v_pk_add_f32 v[252:253], v[252:253], v[24:25] op_sel:[0,0] op_sel_hi:[1,0] neg_lo:[0,1] neg_hi:[0,1]
v_pk_add_f32 v[254:255], v[254:255], v[24:25] op_sel:[0,0] op_sel_hi:[1,0] neg_lo:[0,1] neg_hi:[0,1]
v_permlane32_swap_b32 v93, v92
v_exp_f32 v16, v16
v_exp_f32 v17, v17
v_exp_f32 v18, v18
v_exp_f32 v19, v19
v_exp_f32 v252, v252
v_exp_f32 v253, v253
v_exp_f32 v254, v254
v_exp_f32 v255, v255
v_max_f32 v92, v93, v92
v_mov_b32 v93, v92
v_cvt_pk_bf16_f32 v22, v16, v17
v_cvt_pk_bf16_f32 v23, v18, v19
v_cvt_pk_bf16_f32 v28, v252, v253
v_cvt_pk_bf16_f32 v29, v254, v255
v_and_b32 v20, v22, v40
v_and_b32 v21, v23, v41
v_and_b32 v26, v28, v40
v_and_b32 v27, v29, v41
v_and_b32 v22, v22, v42
v_and_b32 v23, v23, v43
v_and_b32 v28, v28, v42
v_and_b32 v29, v29, v43
v_permlane16_swap_b32 v93, v92
v_pk_add_f32 v[84:85], v[84:85], v[92:93] op_sel:[0,1] op_sel_hi:[1,1] neg_lo:[0,1] neg_hi:[0,1]
v_pk_add_f32 v[86:87], v[86:87], v[92:93] op_sel:[0,1] op_sel_hi:[1,1] neg_lo:[0,1] neg_hi:[0,1]
v_pk_add_f32 v[98:99], v[98:99], v[92:93] op_sel:[0,0] op_sel_hi:[1,0] neg_lo:[0,1] neg_hi:[0,1]
v_pk_add_f32 v[100:101], v[100:101], v[92:93] op_sel:[0,0] op_sel_hi:[1,0] neg_lo:[0,1] neg_hi:[0,1]
v_exp_f32 v84, v84
v_exp_f32 v85, v85
v_exp_f32 v86, v86
v_exp_f32 v87, v87
v_exp_f32 v98, v98
v_exp_f32 v99, v99
v_exp_f32 v100, v100
v_exp_f32 v101, v101
v_mfma_f32_16x16x32_bf16 v[16:19], v[44:47], v[20:23], 0
v_mfma_f32_16x16x32_bf16 v[252:255], v[44:47], v[26:29], 0
v_cvt_pk_bf16_f32 v90, v84, v85
v_cvt_pk_bf16_f32 v91, v86, v87
v_cvt_pk_bf16_f32 v104, v98, v99
v_cvt_pk_bf16_f32 v105, v100, v101
v_mfma_f32_16x16x32_bf16 v[64:67], v[148:151], v[20:23], 0
v_mfma_f32_16x16x32_bf16 v[68:71], v[158:161], v[26:29], 0
v_and_b32 v88, v90, v40
v_and_b32 v89, v91, v41
v_and_b32 v102, v104, v40
v_and_b32 v103, v105, v41
v_mfma_f32_16x16x32_bf16 v[12:15], v[168:171], v[20:23], 0
v_mfma_f32_16x16x32_bf16 v[248:251], v[6:9], v[26:29], 0
v_and_b32 v90, v90, v42
v_and_b32 v91, v91, v43
v_and_b32 v104, v104, v42
v_and_b32 v105, v105, v43
v_mfma_f32_16x16x32_bf16 v[84:87], v[44:47], v[88:91], 0
v_mfma_f32_16x16x32_bf16 v[72:75], v[150:153], v[88:91], 0
v_mfma_f32_16x16x32_bf16 v[98:101], v[44:47], v[102:105], 0
v_mfma_f32_16x16x32_bf16 v[76:79], v[160:163], v[102:105], 0
v_rcp_f32 v16, v16
v_rcp_f32 v252, v252
v_mfma_f32_16x16x32_bf16 v[80:83], v[170:173], v[88:91], 0
v_mfma_f32_16x16x32_bf16 v[94:97], v[8:11], v[102:105], 0
v_pk_mul_f32 v[64:65], v[64:65], v[16:17] op_sel_hi:[1,0]
v_pk_mul_f32 v[66:67], v[66:67], v[16:17] op_sel_hi:[1,0]
v_pk_mul_f32 v[68:69], v[68:69], v[252:253] op_sel_hi:[1,0]
v_pk_mul_f32 v[70:71], v[70:71], v[252:253] op_sel_hi:[1,0]
v_pk_mul_f32 v[12:13], v[12:13], v[16:17] op_sel_hi:[1,0]
v_pk_mul_f32 v[14:15], v[14:15], v[16:17] op_sel_hi:[1,0]
v_pk_mul_f32 v[248:249], v[248:249], v[252:253] op_sel_hi:[1,0]
v_pk_mul_f32 v[250:251], v[250:251], v[252:253] op_sel_hi:[1,0]
v_cvt_pk_bf16_f32 v20, v64, v65
v_cvt_pk_bf16_f32 v21, v66, v67
v_cvt_pk_bf16_f32 v22, v68, v69
v_cvt_pk_bf16_f32 v23, v70, v71
s_mov_b32 s50, 858993458
v_cvt_pk_bf16_f32 v26, v12, v13
v_cvt_pk_bf16_f32 v27, v14, v15
v_cvt_pk_bf16_f32 v28, v248, v249
v_cvt_pk_bf16_f32 v29, v250, v251
v_bfe_u32 v1, s50, v1, 4
v_lshl_add_u32 v1, v1, 7, v111
v_permlane16_swap_b32 v20, v22
v_permlane16_swap_b32 v21, v23
v_rcp_f32 v84, v84
v_rcp_f32 v98, v98
buffer_store_dwordx4 v[20:23], v1, s[16:19], s65 offen offset:2048 sc1
v_permlane16_swap_b32 v26, v28
v_permlane16_swap_b32 v27, v29
buffer_store_dwordx4 v[26:29], v1, s[16:19], s66 offen offset:2048 sc1
v_pk_mul_f32 v[72:73], v[72:73], v[84:85] op_sel_hi:[1,0]
v_pk_mul_f32 v[74:75], v[74:75], v[84:85] op_sel_hi:[1,0]
v_pk_mul_f32 v[76:77], v[76:77], v[98:99] op_sel_hi:[1,0]
v_pk_mul_f32 v[78:79], v[78:79], v[98:99] op_sel_hi:[1,0]
v_pk_mul_f32 v[80:81], v[80:81], v[84:85] op_sel_hi:[1,0]
v_pk_mul_f32 v[82:83], v[82:83], v[84:85] op_sel_hi:[1,0]
v_pk_mul_f32 v[94:95], v[94:95], v[98:99] op_sel_hi:[1,0]
v_pk_mul_f32 v[96:97], v[96:97], v[98:99] op_sel_hi:[1,0]
v_lshrrev_b32 v1, 3, v0
v_cvt_pk_bf16_f32 v88, v72, v73
v_cvt_pk_bf16_f32 v89, v74, v75
v_cvt_pk_bf16_f32 v90, v76, v77
v_cvt_pk_bf16_f32 v91, v78, v79
v_lshlrev_b32 v1, 2, v1
s_mov_b32 s50, 1413760068
v_cvt_pk_bf16_f32 v102, v80, v81
v_cvt_pk_bf16_f32 v103, v82, v83
v_cvt_pk_bf16_f32 v104, v94, v95
v_cvt_pk_bf16_f32 v105, v96, v97
v_bfe_u32 v1, s50, v1, 4
v_lshl_add_u32 v1, v1, 7, v111
v_permlane16_swap_b32 v88, v90
v_permlane16_swap_b32 v89, v91
ds_read_b64 v[144:145], v175 offset:4096
buffer_store_dwordx4 v[88:91], v1, s[16:19], s65 offen offset:3072 sc1
v_permlane16_swap_b32 v102, v104
v_permlane16_swap_b32 v103, v105
ds_read_b64 v[164:165], v175 offset:5120
buffer_store_dwordx4 v[102:105], v1, s[16:19], s66 offen offset:3072 sc1
s_waitcnt vmcnt(6) lgkmcnt(0)
v_mfma_f32_16x16x32_bf16 v[12:15], v[240:243], v[48:51], 0
v_mfma_f32_16x16x32_bf16 v[16:19], v[112:115], v[48:51], 0
v_mfma_f32_16x16x32_bf16 v[248:251], v[244:247], v[52:55], 0
v_mfma_f32_16x16x32_bf16 v[252:255], v[116:119], v[52:55], 0
v_mov_b32 v80, 0
v_mov_b32 v81, 0
v_mov_b32 v82, 0
v_mov_b32 v83, 0
v_dot2c_f32_bf16 v80, v176, v208
v_dot2c_f32_bf16 v81, v177, v209
v_cndmask_b32 v16, v16, v12, s[56:57]
v_cndmask_b32 v17, v17, v13, s[58:59]
v_cndmask_b32 v18, v18, v14, s[60:61]
v_cndmask_b32 v19, v19, v15, s[62:63]
v_cndmask_b32 v252, v252, v248, s[56:57]
v_cndmask_b32 v253, v253, v249, s[58:59]
v_cndmask_b32 v254, v254, v250, s[60:61]
v_cndmask_b32 v255, v255, v251, s[62:63]
v_pk_fma_f32 v[16:17], v[16:17], s[68:69], v[36:37]
v_pk_fma_f32 v[18:19], v[18:19], s[68:69], v[38:39]
v_pk_fma_f32 v[252:253], v[252:253], s[68:69], v[36:37]
v_pk_fma_f32 v[254:255], v[254:255], s[68:69], v[38:39]
v_max3_f32 v24, v16, v17, v18
v_max3_f32 v30, v252, v253, v254
v_max_f32 v24, v24, v19
v_max_f32 v30, v30, v255
v_dot2c_f32_bf16 v82, v178, v210
v_dot2c_f32_bf16 v83, v179, v211
v_permlane16_swap_b32 v24, v30
v_max_f32 v24, v24, v30
v_mov_b32 v25, v24
v_dot2c_f32_bf16 v80, v180, v212
v_dot2c_f32_bf16 v81, v181, v213
v_dot2c_f32_bf16 v82, v182, v214
v_dot2c_f32_bf16 v83, v183, v215
v_dot2c_f32_bf16 v80, v184, v216
v_dot2c_f32_bf16 v81, v185, v217
v_dot2c_f32_bf16 v82, v186, v218
v_dot2c_f32_bf16 v83, v187, v219
v_permlane32_swap_b32 v25, v24
v_dot2c_f32_bf16 v80, v188, v220
v_dot2c_f32_bf16 v81, v189, v221
v_dot2c_f32_bf16 v82, v190, v222
v_dot2c_f32_bf16 v83, v191, v223
v_max_f32 v24, v25, v24
v_dot2c_f32_bf16 v80, v192, v224
v_dot2c_f32_bf16 v81, v193, v225
v_dot2c_f32_bf16 v82, v194, v226
v_dot2c_f32_bf16 v83, v195, v227
v_mov_b32 v25, v24
v_dot2c_f32_bf16 v80, v196, v228
v_dot2c_f32_bf16 v81, v197, v229
v_dot2c_f32_bf16 v82, v198, v230
v_dot2c_f32_bf16 v83, v199, v231
v_dot2c_f32_bf16 v80, v200, v232
v_dot2c_f32_bf16 v81, v201, v233
v_dot2c_f32_bf16 v82, v202, v234
v_dot2c_f32_bf16 v83, v203, v235
v_dot2c_f32_bf16 v80, v204, v236
v_dot2c_f32_bf16 v81, v205, v237
v_dot2c_f32_bf16 v82, v206, v238
v_dot2c_f32_bf16 v83, v207, v239
v_permlane16_swap_b32 v25, v24
v_pk_add_f32 v[16:17], v[16:17], v[24:25] op_sel:[0,1] op_sel_hi:[1,1] neg_lo:[0,1] neg_hi:[0,1]
v_pk_add_f32 v[18:19], v[18:19], v[24:25] op_sel:[0,1] op_sel_hi:[1,1] neg_lo:[0,1] neg_hi:[0,1]
v_pk_add_f32 v[252:253], v[252:253], v[24:25] op_sel:[0,0] op_sel_hi:[1,0] neg_lo:[0,1] neg_hi:[0,1]
v_pk_add_f32 v[254:255], v[254:255], v[24:25] op_sel:[0,0] op_sel_hi:[1,0] neg_lo:[0,1] neg_hi:[0,1]
v_exp_f32 v16, v16
v_exp_f32 v17, v17
v_exp_f32 v18, v18
v_exp_f32 v19, v19
v_exp_f32 v252, v252
v_exp_f32 v253, v253
v_exp_f32 v254, v254
v_exp_f32 v255, v255
v_add_f32 v80, v80, v81
v_add_f32 v82, v82, v83
v_cvt_pk_bf16_f32 v22, v16, v17
v_cvt_pk_bf16_f32 v23, v18, v19
v_cvt_pk_bf16_f32 v28, v252, v253
v_cvt_pk_bf16_f32 v29, v254, v255
v_add_f32 v80, v80, v82
v_mov_b32 v154, v144
v_mov_b32 v155, v145
v_and_b32 v20, v22, v40
v_and_b32 v21, v23, v41
v_and_b32 v26, v28, v40
v_and_b32 v27, v29, v41
v_mov_b32 v2, v164
v_mov_b32 v3, v165
v_and_b32 v22, v22, v42
v_and_b32 v23, v23, v43
v_and_b32 v28, v28, v42
v_and_b32 v29, v29, v43
v_add_f32_dpp v80, v80, v80 row_ror:8 row_mask:0xf bank_mask:0xf
v_permlane32_swap_b32 v154, v144
v_permlane32_swap_b32 v155, v145
v_permlane32_swap_b32 v2, v164
v_permlane32_swap_b32 v3, v165
v_mfma_f32_16x16x32_bf16 v[16:19], v[44:47], v[20:23], 0
v_mfma_f32_16x16x32_bf16 v[252:255], v[44:47], v[26:29], 0
v_add_f32_dpp v80, v80, v80 row_ror:4 row_mask:0xf bank_mask:0xf
v_mfma_f32_16x16x32_bf16 v[48:51], v[144:147], v[20:23], 0
v_mfma_f32_16x16x32_bf16 v[52:55], v[154:157], v[26:29], 0
v_mfma_f32_16x16x32_bf16 v[12:15], v[164:167], v[20:23], 0
v_mfma_f32_16x16x32_bf16 v[248:251], v[2:5], v[26:29], 0
v_add_f32_dpp v80, v80, v80 row_ror:2 row_mask:0xf bank_mask:0xf
v_lshrrev_b32 v1, 3, v0
v_rcp_f32 v16, v16
v_add_f32_dpp v80, v80, v80 row_ror:1 row_mask:0xf bank_mask:0xf
v_cvt_pk_bf16_f32 v80, v80, v80
v_rcp_f32 v252, v252
v_lshlrev_b32 v80, 16, v80
v_mul_f32 v80, 0xbfb8aa3b, v80
v_pk_mul_f32 v[48:49], v[48:49], v[16:17] op_sel_hi:[1,0]
v_pk_mul_f32 v[50:51], v[50:51], v[16:17] op_sel_hi:[1,0]
v_pk_mul_f32 v[52:53], v[52:53], v[252:253] op_sel_hi:[1,0]
v_pk_mul_f32 v[54:55], v[54:55], v[252:253] op_sel_hi:[1,0]
v_exp_f32 v80, v80
v_pk_mul_f32 v[12:13], v[12:13], v[16:17] op_sel_hi:[1,0]
v_pk_mul_f32 v[14:15], v[14:15], v[16:17] op_sel_hi:[1,0]
v_pk_mul_f32 v[248:249], v[248:249], v[252:253] op_sel_hi:[1,0]
v_pk_mul_f32 v[250:251], v[250:251], v[252:253] op_sel_hi:[1,0]
v_cvt_pk_bf16_f32 v20, v48, v49
v_cvt_pk_bf16_f32 v21, v50, v51
v_cvt_pk_bf16_f32 v22, v52, v53
v_cvt_pk_bf16_f32 v23, v54, v55
v_lshlrev_b32 v1, 2, v1
s_mov_b32 s50, 286330880
v_cvt_pk_bf16_f32 v26, v12, v13
v_cvt_pk_bf16_f32 v27, v14, v15
v_cvt_pk_bf16_f32 v28, v248, v249
v_cvt_pk_bf16_f32 v29, v250, v251
v_add_f32 v80, 1.0, v80
v_bfe_u32 v1, s50, v1, 4
v_rcp_f32 v80, v80
v_lshl_add_u32 v1, v1, 7, v111
v_permlane16_swap_b32 v20, v22
v_permlane16_swap_b32 v21, v23
buffer_store_dwordx4 v[20:23], v1, s[16:19], s65 offen offset:0 sc1
v_permlane16_swap_b32 v26, v28
v_permlane16_swap_b32 v27, v29
v_cvt_pk_bf16_f32 v80, v80, v80
v_and_b32 v81, 15, v0
buffer_store_dwordx4 v[26:29], v1, s[16:19], s66 offen offset:0 sc1
v_lshlrev_b32 v80, 16, v80
v_cmp_eq_u32 vcc, 0, v81
s_mov_b32 s50, 23592960
s_and_saveexec_b64 s[72:73], vcc
buffer_store_dword v80, v108, s[16:19], s50 offen sc1
s_mov_b64 exec, s[72:73]
s_and_b32 s41, s32, 7
s_cmp_eq_u32 s41, 3
s_cselect_b32 s41, 1024, 0
s_add_u32 s41, s41, 23625728
s_mov_b32 s52, 0
s_branch L_p3_entry
L_qkv_m1:
s_waitcnt vmcnt(15)
s_mov_b32 s4, s100
s_mov_b32 s5, s101
s_mov_b32 s6, 256
s_mov_b32 s7, 0x00020000
s_lshr_b32 s24, s2, 3
s_and_b32 s24, s24, 7
s_cmp_eq_u32 s28, 0
s_cselect_b32 s24, s24, -1
s_lshr_b32 s25, s2, 3
s_and_b32 s25, s25, 3
s_add_u32 s25, s25, 3
v_mov_b32 v17, 1
v_mov_b32 v18, 0
s_lshl_b32 s27, s32, 3
s_add_u32 s27, s27, s31
v_mul_u32_u24 v31, 43, v0
v_lshrrev_b32 v31, 8, v31
v_mul_u32_u24 v14, 6, v31
v_sub_u32 v14, v0, v14
s_lshl_b32 s50, s27, 3
v_add_u32 v31, s50, v31
v_mul_u32_u24 v31, 6144, v31
v_lshlrev_b32 v14, 10, v14
v_add_u32 v31, v31, v14
v_add_u32 v31, 4480, v31
v_mov_b32 v14, 0x7ff00000
v_cmp_gt_u32 vcc, 48, v0
s_lshr_b32 s27, s27, 4
s_max_u32 s27, s27, 1
v_cndmask_b32 v31, v14, v31, vcc
s_sub_u32 s27, s27, 1
s_cmp_eq_u32 s28, 1
s_cselect_b32 s27, s27, -1
s_barrier
ds_read_b64_tr_b16 a[80:81], v11 offset:0
ds_read_b128 a[0:3], v9 offset:0
ds_read_b64_tr_b16 a[82:83], v11 offset:512
ds_read_b128 a[4:7], v9 offset:2048
ds_read_b64_tr_b16 a[84:85], v12 offset:0
ds_read_b128 a[8:11], v9 offset:4096
ds_read_b64_tr_b16 a[86:87], v12 offset:512
ds_read_b64_tr_b16 a[88:89], v11 offset:1024
ds_read_b128 a[12:15], v9 offset:6144
ds_read_b64_tr_b16 a[90:91], v11 offset:1536
ds_read_b128 a[16:19], v9 offset:8192
ds_read_b64_tr_b16 a[92:93], v12 offset:1024
ds_read_b128 a[20:23], v9 offset:10240
ds_read_b64_tr_b16 a[94:95], v12 offset:1536
ds_read_b64_tr_b16 a[96:97], v11 offset:2048
ds_read_b128 a[24:27], v9 offset:12288
ds_read_b64_tr_b16 a[98:99], v11 offset:2560
ds_read_b128 a[28:31], v9 offset:14336
ds_read_b64_tr_b16 a[100:101], v12 offset:2048
ds_read_b128 a[32:35], v9 offset:16384
ds_read_b64_tr_b16 a[102:103], v12 offset:2560
s_add_u32 s38, s38, 32
s_and_b32 s38, s38, 1023
s_mul_i32 s39, s38, 6144
s_mov_b32 m0, s37
s_nop 0
buffer_load_dwordx4 v5, s[12:15], s39 offen offset:0 lds
buffer_load_dwordx4 v6, s[12:15], s39 offen offset:1024 lds
buffer_load_dwordx4 v7, s[12:15], s39 offen offset:2048 lds
s_add_u32 s40, s40, 128
s_and_b32 s40, s40, 2047
s_add_u32 s41, s40, s52
s_add_u32 s42, s41, 65536
s_mov_b32 s47, 69632
s_add_u32 s44, s47, s53
s_add_u32 s45, s44, 4096
s_add_u32 s46, s47, s54
s_mov_b32 m0, s44
s_nop 0
buffer_load_dwordx4 v1, s[8:11], s41 offen offset:0 lds
buffer_load_dwordx4 v2, s[8:11], s41 offen offset:1024 lds
buffer_load_dwordx4 v3, s[8:11], s41 offen offset:2048 lds
buffer_load_dwordx4 v4, s[8:11], s41 offen offset:3072 lds
s_mov_b32 s47, 0
s_lshl_b32 s50, s2, 7
s_add_u32 s50, s50, 23625728
v_mov_b32 v14, 0
v_lshlrev_b32 v15, 2, v0
v_and_b32 v15, 127, v15
buffer_store_dword v14, v15, s[16:19], s50 offen sc1
s_waitcnt vmcnt(20) lgkmcnt(0)
s_barrier
s_mov_b32 s33, 0
L_loop_qkv1:
s_cmp_eq_u32 s33, 7
s_cselect_b32 s10, 0, s10
s_cselect_b32 s14, 0, s14
v_mfma_f32_16x16x32_bf16 v[48:51], a[80:83], a[0:3], v[48:51]
ds_read_b64_tr_b16 a[108:109], v11 offset:12288
v_mfma_f32_16x16x32_bf16 v[52:55], a[80:83], a[4:7], v[52:55]
v_mfma_f32_16x16x32_bf16 v[56:59], a[80:83], a[8:11], v[56:59]
ds_read_b128 a[40:43], v10 offset:0
v_mfma_f32_16x16x32_bf16 v[60:63], a[80:83], a[12:15], v[60:63]
v_mfma_f32_16x16x32_bf16 v[64:67], a[80:83], a[16:19], v[64:67]
ds_read_b64_tr_b16 a[110:111], v11 offset:12800
v_mfma_f32_16x16x32_bf16 v[68:71], a[80:83], a[20:23], v[68:71]
v_mfma_f32_16x16x32_bf16 v[72:75], a[80:83], a[24:27], v[72:75]
ds_read_b128 a[44:47], v10 offset:2048
v_mfma_f32_16x16x32_bf16 v[76:79], a[80:83], a[28:31], v[76:79]
v_mfma_f32_16x16x32_bf16 v[80:83], a[84:87], a[0:3], v[80:83]
ds_read_b64_tr_b16 a[112:113], v12 offset:12288
s_add_u32 s38, s38, 32
s_and_b32 s38, s38, 1023
s_mul_i32 s39, s38, 6144
s_mov_b32 m0, s34
v_mfma_f32_16x16x32_bf16 v[84:87], a[84:87], a[4:7], v[84:87]
v_mfma_f32_16x16x32_bf16 v[88:91], a[84:87], a[8:11], v[88:91]
ds_read_b128 a[48:51], v10 offset:4096
s_cmp_eq_u32 s33, s25
s_cbranch_scc0 L_nopf_qkv1
buffer_load_dword v28, v30, s[96:99], s71 offen
buffer_load_dword v28, v29, s[92:95], s55 offen
L_nopf_qkv1:
v_mfma_f32_16x16x32_bf16 v[92:95], a[84:87], a[12:15], v[92:95]
v_mfma_f32_16x16x32_bf16 v[96:99], a[84:87], a[16:19], v[96:99]
buffer_load_dwordx4 v5, s[12:15], s39 offen offset:0 lds
ds_read_b64_tr_b16 a[114:115], v12 offset:12800
v_mfma_f32_16x16x32_bf16 v[100:103], a[84:87], a[20:23], v[100:103]
v_mfma_f32_16x16x32_bf16 v[104:107], a[84:87], a[24:27], v[104:107]
ds_read_b64_tr_b16 a[116:117], v11 offset:13312
v_mfma_f32_16x16x32_bf16 v[108:111], a[84:87], a[28:31], v[108:111]
v_mfma_f32_16x16x32_bf16 v[112:115], a[88:91], a[0:3], v[112:115]
buffer_load_dwordx4 v6, s[12:15], s39 offen offset:1024 lds
ds_read_b128 a[52:55], v10 offset:6144
v_mfma_f32_16x16x32_bf16 v[116:119], a[88:91], a[4:7], v[116:119]
v_mfma_f32_16x16x32_bf16 v[120:123], a[88:91], a[8:11], v[120:123]
ds_read_b64_tr_b16 a[118:119], v11 offset:13824
v_mfma_f32_16x16x32_bf16 v[124:127], a[88:91], a[12:15], v[124:127]
v_mfma_f32_16x16x32_bf16 v[128:131], a[88:91], a[16:19], v[128:131]
buffer_load_dwordx4 v7, s[12:15], s39 offen offset:2048 lds
ds_read_b128 a[56:59], v10 offset:8192
v_mfma_f32_16x16x32_bf16 v[132:135], a[88:91], a[20:23], v[132:135]
v_mfma_f32_16x16x32_bf16 v[136:139], a[88:91], a[24:27], v[136:139]
ds_read_b64_tr_b16 a[120:121], v12 offset:13312
v_mfma_f32_16x16x32_bf16 v[140:143], a[88:91], a[28:31], v[140:143]
s_mov_b32 m0, s45
v_mfma_f32_16x16x32_bf16 v[144:147], a[92:95], a[0:3], v[144:147]
ds_read_b128 a[60:63], v10 offset:10240
v_mfma_f32_16x16x32_bf16 v[148:151], a[92:95], a[4:7], v[148:151]
v_mfma_f32_16x16x32_bf16 v[152:155], a[92:95], a[8:11], v[152:155]
ds_read_b64_tr_b16 a[122:123], v12 offset:13824
v_mfma_f32_16x16x32_bf16 v[156:159], a[92:95], a[12:15], v[156:159]
buffer_load_dwordx4 v1, s[8:11], s42 offen offset:0 lds
v_mfma_f32_16x16x32_bf16 v[160:163], a[92:95], a[16:19], v[160:163]
ds_read_b64_tr_b16 a[124:125], v11 offset:14336
v_mfma_f32_16x16x32_bf16 v[164:167], a[92:95], a[20:23], v[164:167]
v_mfma_f32_16x16x32_bf16 v[168:171], a[92:95], a[24:27], v[168:171]
ds_read_b128 a[64:67], v10 offset:12288
v_mfma_f32_16x16x32_bf16 v[172:175], a[92:95], a[28:31], v[172:175]
buffer_load_dwordx4 v2, s[8:11], s42 offen offset:1024 lds
v_mfma_f32_16x16x32_bf16 v[176:179], a[0:3], a[96:99], v[176:179]
ds_read_b64_tr_b16 a[126:127], v11 offset:14848
v_mfma_f32_16x16x32_bf16 v[180:183], a[4:7], a[96:99], v[180:183]
v_mfma_f32_16x16x32_bf16 v[184:187], a[8:11], a[96:99], v[184:187]
ds_read_b128 a[68:71], v10 offset:14336
v_mfma_f32_16x16x32_bf16 v[188:191], a[12:15], a[96:99], v[188:191]
buffer_load_dwordx4 v3, s[8:11], s42 offen offset:2048 lds
v_mfma_f32_16x16x32_bf16 v[192:195], a[16:19], a[96:99], v[192:195]
ds_read_b64_tr_b16 a[128:129], v12 offset:14336
v_mfma_f32_16x16x32_bf16 v[196:199], a[20:23], a[96:99], v[196:199]
v_mfma_f32_16x16x32_bf16 v[200:203], a[24:27], a[96:99], v[200:203]
ds_read_b128 a[72:75], v10 offset:16384
v_mfma_f32_16x16x32_bf16 v[204:207], a[28:31], a[96:99], v[204:207]
buffer_load_dwordx4 v4, s[8:11], s42 offen offset:3072 lds
v_mfma_f32_16x16x32_bf16 v[208:211], a[0:3], a[100:103], v[208:211]
ds_read_b64_tr_b16 a[130:131], v12 offset:14848
v_mfma_f32_16x16x32_bf16 v[212:215], a[4:7], a[100:103], v[212:215]
v_mfma_f32_16x16x32_bf16 v[216:219], a[8:11], a[100:103], v[216:219]
s_mov_b32 m0, s46
v_mfma_f32_16x16x32_bf16 v[220:223], a[12:15], a[100:103], v[220:223]
v_mfma_f32_16x16x32_bf16 v[224:227], a[16:19], a[100:103], v[224:227]
v_mfma_f32_16x16x32_bf16 v[228:231], a[20:23], a[100:103], v[228:231]
v_mfma_f32_16x16x32_bf16 v[232:235], a[24:27], a[100:103], v[232:235]
buffer_load_dwordx4 v8, s[8:11], s40 offen lds
v_mfma_f32_16x16x32_bf16 v[236:239], a[28:31], a[100:103], v[236:239]
v_mfma_f32_16x16x32_bf16 v[240:243], a[32:35], a[96:99], v[240:243]
v_mfma_f32_16x16x32_bf16 v[244:247], a[32:35], a[100:103], v[244:247]
s_waitcnt vmcnt(15) lgkmcnt(0)
s_barrier
s_add_u32 s44, s47, s53
s_add_u32 s45, s44, 4096
s_add_u32 s46, s47, s54
s_add_u32 s50, s47, 34816
v_mfma_f32_16x16x32_bf16 v[48:51], a[108:111], a[40:43], v[48:51]
s_cmp_eq_u32 s50, 104448
s_cselect_b32 s50, 0, s50
v_mfma_f32_16x16x32_bf16 v[52:55], a[108:111], a[44:47], v[52:55]
s_sub_u32 s48, s50, s47
s_mov_b32 s47, s50
v_mfma_f32_16x16x32_bf16 v[56:59], a[108:111], a[48:51], v[56:59]
v_add_u32 v9, s48, v9
v_add_u32 v10, s48, v10
v_mfma_f32_16x16x32_bf16 v[60:63], a[108:111], a[52:55], v[60:63]
s_add_u32 s40, s40, 128
v_mfma_f32_16x16x32_bf16 v[64:67], a[108:111], a[56:59], v[64:67]
s_and_b32 s40, s40, 2047
s_add_u32 s41, s40, s52
ds_read_b64_tr_b16 a[80:81], v11 offset:24576
v_mfma_f32_16x16x32_bf16 v[68:71], a[108:111], a[60:63], v[68:71]
s_add_u32 s42, s41, 65536
v_mfma_f32_16x16x32_bf16 v[72:75], a[108:111], a[64:67], v[72:75]
ds_read_b128 a[0:3], v9 offset:0
v_mfma_f32_16x16x32_bf16 v[76:79], a[108:111], a[68:71], v[76:79]
v_mfma_f32_16x16x32_bf16 v[80:83], a[112:115], a[40:43], v[80:83]
ds_read_b64_tr_b16 a[82:83], v11 offset:25088
v_mfma_f32_16x16x32_bf16 v[84:87], a[112:115], a[44:47], v[84:87]
s_add_u32 s38, s38, 32
s_and_b32 s38, s38, 1023
s_mul_i32 s39, s38, 6144
s_mov_b32 m0, s35
v_mfma_f32_16x16x32_bf16 v[88:91], a[112:115], a[48:51], v[88:91]
ds_read_b128 a[4:7], v9 offset:2048
v_mfma_f32_16x16x32_bf16 v[92:95], a[112:115], a[52:55], v[92:95]
ds_read_b64_tr_b16 a[84:85], v12 offset:24576
v_mfma_f32_16x16x32_bf16 v[96:99], a[112:115], a[56:59], v[96:99]
v_mfma_f32_16x16x32_bf16 v[100:103], a[112:115], a[60:63], v[100:103]
ds_read_b128 a[8:11], v9 offset:4096
buffer_load_dwordx4 v5, s[12:15], s39 offen offset:0 lds
v_mfma_f32_16x16x32_bf16 v[104:107], a[112:115], a[64:67], v[104:107]
v_mfma_f32_16x16x32_bf16 v[108:111], a[112:115], a[68:71], v[108:111]
ds_read_b64_tr_b16 a[86:87], v12 offset:25088
v_mfma_f32_16x16x32_bf16 v[112:115], a[116:119], a[40:43], v[112:115]
v_mfma_f32_16x16x32_bf16 v[116:119], a[116:119], a[44:47], v[116:119]
ds_read_b64_tr_b16 a[88:89], v11 offset:25600
v_mfma_f32_16x16x32_bf16 v[120:123], a[116:119], a[48:51], v[120:123]
buffer_load_dwordx4 v6, s[12:15], s39 offen offset:1024 lds
ds_read_b128 a[12:15], v9 offset:6144
v_mfma_f32_16x16x32_bf16 v[124:127], a[116:119], a[52:55], v[124:127]
v_mfma_f32_16x16x32_bf16 v[128:131], a[116:119], a[56:59], v[128:131]
ds_read_b64_tr_b16 a[90:91], v11 offset:26112
v_mfma_f32_16x16x32_bf16 v[132:135], a[116:119], a[60:63], v[132:135]
v_mfma_f32_16x16x32_bf16 v[136:139], a[116:119], a[64:67], v[136:139]
ds_read_b128 a[16:19], v9 offset:8192
v_mfma_f32_16x16x32_bf16 v[140:143], a[116:119], a[68:71], v[140:143]
buffer_load_dwordx4 v7, s[12:15], s39 offen offset:2048 lds
v_mfma_f32_16x16x32_bf16 v[144:147], a[120:123], a[40:43], v[144:147]
ds_read_b64_tr_b16 a[92:93], v12 offset:25600
v_mfma_f32_16x16x32_bf16 v[148:151], a[120:123], a[44:47], v[148:151]
v_mfma_f32_16x16x32_bf16 v[152:155], a[120:123], a[48:51], v[152:155]
ds_read_b128 a[20:23], v9 offset:10240
v_mfma_f32_16x16x32_bf16 v[156:159], a[120:123], a[52:55], v[156:159]
s_mov_b32 m0, s44
ds_read_b64_tr_b16 a[94:95], v12 offset:26112
v_mfma_f32_16x16x32_bf16 v[160:163], a[120:123], a[56:59], v[160:163]
v_mfma_f32_16x16x32_bf16 v[164:167], a[120:123], a[60:63], v[164:167]
s_cmp_eq_u32 s33, s27
s_cbranch_scc0 L_noc3_qkv1
buffer_load_dword a202, v31, s[12:15], 0 offen
L_noc3_qkv1:
ds_read_b64_tr_b16 a[96:97], v11 offset:26624
v_mfma_f32_16x16x32_bf16 v[168:171], a[120:123], a[64:67], v[168:171]
v_mfma_f32_16x16x32_bf16 v[172:175], a[120:123], a[68:71], v[172:175]
ds_read_b128 a[24:27], v9 offset:12288
v_mfma_f32_16x16x32_bf16 v[176:179], a[40:43], a[124:127], v[176:179]
buffer_load_dwordx4 v1, s[8:11], s41 offen offset:0 lds
v_mfma_f32_16x16x32_bf16 v[180:183], a[44:47], a[124:127], v[180:183]
ds_read_b64_tr_b16 a[98:99], v11 offset:27136
v_mfma_f32_16x16x32_bf16 v[184:187], a[48:51], a[124:127], v[184:187]
ds_read_b128 a[28:31], v9 offset:14336
v_mfma_f32_16x16x32_bf16 v[188:191], a[52:55], a[124:127], v[188:191]
v_mfma_f32_16x16x32_bf16 v[192:195], a[56:59], a[124:127], v[192:195]
ds_read_b64_tr_b16 a[100:101], v12 offset:26624
buffer_load_dwordx4 v2, s[8:11], s41 offen offset:1024 lds
v_mfma_f32_16x16x32_bf16 v[196:199], a[60:63], a[124:127], v[196:199]
v_mfma_f32_16x16x32_bf16 v[200:203], a[64:67], a[124:127], v[200:203]
ds_read_b128 a[32:35], v9 offset:16384
v_mfma_f32_16x16x32_bf16 v[204:207], a[68:71], a[124:127], v[204:207]
v_mfma_f32_16x16x32_bf16 v[208:211], a[40:43], a[128:131], v[208:211]
ds_read_b64_tr_b16 a[102:103], v12 offset:27136
v_mfma_f32_16x16x32_bf16 v[212:215], a[44:47], a[128:131], v[212:215]
buffer_load_dwordx4 v3, s[8:11], s41 offen offset:2048 lds
v_mfma_f32_16x16x32_bf16 v[216:219], a[48:51], a[128:131], v[216:219]
v_mfma_f32_16x16x32_bf16 v[220:223], a[52:55], a[128:131], v[220:223]
v_mfma_f32_16x16x32_bf16 v[224:227], a[56:59], a[128:131], v[224:227]
v_mfma_f32_16x16x32_bf16 v[228:231], a[60:63], a[128:131], v[228:231]
v_mfma_f32_16x16x32_bf16 v[232:235], a[64:67], a[128:131], v[232:235]
buffer_load_dwordx4 v4, s[8:11], s41 offen offset:3072 lds
v_mfma_f32_16x16x32_bf16 v[236:239], a[68:71], a[128:131], v[236:239]
v_mfma_f32_16x16x32_bf16 v[240:243], a[72:75], a[124:127], v[240:243]
v_mfma_f32_16x16x32_bf16 v[244:247], a[72:75], a[128:131], v[244:247]
s_waitcnt vmcnt(15) lgkmcnt(0)
s_barrier
v_mfma_f32_16x16x32_bf16 v[48:51], a[80:83], a[0:3], v[48:51]
ds_read_b64_tr_b16 a[108:109], v11 offset:36864
v_mfma_f32_16x16x32_bf16 v[52:55], a[80:83], a[4:7], v[52:55]
v_mfma_f32_16x16x32_bf16 v[56:59], a[80:83], a[8:11], v[56:59]
ds_read_b128 a[40:43], v10 offset:0
v_mfma_f32_16x16x32_bf16 v[60:63], a[80:83], a[12:15], v[60:63]
v_mfma_f32_16x16x32_bf16 v[64:67], a[80:83], a[16:19], v[64:67]
ds_read_b64_tr_b16 a[110:111], v11 offset:37376
v_mfma_f32_16x16x32_bf16 v[68:71], a[80:83], a[20:23], v[68:71]
v_mfma_f32_16x16x32_bf16 v[72:75], a[80:83], a[24:27], v[72:75]
ds_read_b128 a[44:47], v10 offset:2048
v_mfma_f32_16x16x32_bf16 v[76:79], a[80:83], a[28:31], v[76:79]
v_mfma_f32_16x16x32_bf16 v[80:83], a[84:87], a[0:3], v[80:83]
ds_read_b64_tr_b16 a[112:113], v12 offset:36864
s_add_u32 s38, s38, 32
s_and_b32 s38, s38, 1023
s_mul_i32 s39, s38, 6144
s_mov_b32 m0, s36
v_mfma_f32_16x16x32_bf16 v[84:87], a[84:87], a[4:7], v[84:87]
v_mfma_f32_16x16x32_bf16 v[88:91], a[84:87], a[8:11], v[88:91]
ds_read_b128 a[48:51], v10 offset:4096
v_mfma_f32_16x16x32_bf16 v[92:95], a[84:87], a[12:15], v[92:95]
v_mfma_f32_16x16x32_bf16 v[96:99], a[84:87], a[16:19], v[96:99]
buffer_load_dwordx4 v5, s[12:15], s39 offen offset:0 lds
ds_read_b64_tr_b16 a[114:115], v12 offset:37376
v_mfma_f32_16x16x32_bf16 v[100:103], a[84:87], a[20:23], v[100:103]
v_mfma_f32_16x16x32_bf16 v[104:107], a[84:87], a[24:27], v[104:107]
ds_read_b64_tr_b16 a[116:117], v11 offset:37888
v_mfma_f32_16x16x32_bf16 v[108:111], a[84:87], a[28:31], v[108:111]
s_cmp_eq_u32 s33, s24
s_cbranch_scc0 L_noinit_qkv1
s_mov_b64 exec, 1
buffer_atomic_add v17, v18, s[4:7], 0 offen sc1
s_mov_b64 exec, -1
L_noinit_qkv1:
v_mfma_f32_16x16x32_bf16 v[112:115], a[88:91], a[0:3], v[112:115]
buffer_load_dwordx4 v6, s[12:15], s39 offen offset:1024 lds
ds_read_b128 a[52:55], v10 offset:6144
v_mfma_f32_16x16x32_bf16 v[116:119], a[88:91], a[4:7], v[116:119]
v_mfma_f32_16x16x32_bf16 v[120:123], a[88:91], a[8:11], v[120:123]
ds_read_b64_tr_b16 a[118:119], v11 offset:38400
v_mfma_f32_16x16x32_bf16 v[124:127], a[88:91], a[12:15], v[124:127]
v_mfma_f32_16x16x32_bf16 v[128:131], a[88:91], a[16:19], v[128:131]
buffer_load_dwordx4 v7, s[12:15], s39 offen offset:2048 lds
ds_read_b128 a[56:59], v10 offset:8192
v_mfma_f32_16x16x32_bf16 v[132:135], a[88:91], a[20:23], v[132:135]
v_mfma_f32_16x16x32_bf16 v[136:139], a[88:91], a[24:27], v[136:139]
ds_read_b64_tr_b16 a[120:121], v12 offset:37888
v_mfma_f32_16x16x32_bf16 v[140:143], a[88:91], a[28:31], v[140:143]
s_mov_b32 m0, s45
v_mfma_f32_16x16x32_bf16 v[144:147], a[92:95], a[0:3], v[144:147]
ds_read_b128 a[60:63], v10 offset:10240
v_mfma_f32_16x16x32_bf16 v[148:151], a[92:95], a[4:7], v[148:151]
v_mfma_f32_16x16x32_bf16 v[152:155], a[92:95], a[8:11], v[152:155]
ds_read_b64_tr_b16 a[122:123], v12 offset:38400
v_mfma_f32_16x16x32_bf16 v[156:159], a[92:95], a[12:15], v[156:159]
buffer_load_dwordx4 v1, s[8:11], s42 offen offset:0 lds
v_mfma_f32_16x16x32_bf16 v[160:163], a[92:95], a[16:19], v[160:163]
ds_read_b64_tr_b16 a[124:125], v11 offset:38912
v_mfma_f32_16x16x32_bf16 v[164:167], a[92:95], a[20:23], v[164:167]
v_mfma_f32_16x16x32_bf16 v[168:171], a[92:95], a[24:27], v[168:171]
ds_read_b128 a[64:67], v10 offset:12288
v_mfma_f32_16x16x32_bf16 v[172:175], a[92:95], a[28:31], v[172:175]
buffer_load_dwordx4 v2, s[8:11], s42 offen offset:1024 lds
v_mfma_f32_16x16x32_bf16 v[176:179], a[0:3], a[96:99], v[176:179]
ds_read_b64_tr_b16 a[126:127], v11 offset:39424
v_mfma_f32_16x16x32_bf16 v[180:183], a[4:7], a[96:99], v[180:183]
v_mfma_f32_16x16x32_bf16 v[184:187], a[8:11], a[96:99], v[184:187]
ds_read_b128 a[68:71], v10 offset:14336
v_mfma_f32_16x16x32_bf16 v[188:191], a[12:15], a[96:99], v[188:191]
buffer_load_dwordx4 v3, s[8:11], s42 offen offset:2048 lds
v_mfma_f32_16x16x32_bf16 v[192:195], a[16:19], a[96:99], v[192:195]
ds_read_b64_tr_b16 a[128:129], v12 offset:38912
v_mfma_f32_16x16x32_bf16 v[196:199], a[20:23], a[96:99], v[196:199]
v_mfma_f32_16x16x32_bf16 v[200:203], a[24:27], a[96:99], v[200:203]
ds_read_b128 a[72:75], v10 offset:16384
v_mfma_f32_16x16x32_bf16 v[204:207], a[28:31], a[96:99], v[204:207]
buffer_load_dwordx4 v4, s[8:11], s42 offen offset:3072 lds
v_mfma_f32_16x16x32_bf16 v[208:211], a[0:3], a[100:103], v[208:211]
ds_read_b64_tr_b16 a[130:131], v12 offset:39424
v_mfma_f32_16x16x32_bf16 v[212:215], a[4:7], a[100:103], v[212:215]
v_mfma_f32_16x16x32_bf16 v[216:219], a[8:11], a[100:103], v[216:219]
s_mov_b32 m0, s46
v_mfma_f32_16x16x32_bf16 v[220:223], a[12:15], a[100:103], v[220:223]
v_mfma_f32_16x16x32_bf16 v[224:227], a[16:19], a[100:103], v[224:227]
v_mfma_f32_16x16x32_bf16 v[228:231], a[20:23], a[100:103], v[228:231]
v_mfma_f32_16x16x32_bf16 v[232:235], a[24:27], a[100:103], v[232:235]
buffer_load_dwordx4 v8, s[8:11], s40 offen lds
v_mfma_f32_16x16x32_bf16 v[236:239], a[28:31], a[100:103], v[236:239]
v_mfma_f32_16x16x32_bf16 v[240:243], a[32:35], a[96:99], v[240:243]
v_mfma_f32_16x16x32_bf16 v[244:247], a[32:35], a[100:103], v[244:247]
s_waitcnt vmcnt(15) lgkmcnt(0)
s_barrier
s_add_u32 s44, s47, s53
s_add_u32 s45, s44, 4096
s_add_u32 s46, s47, s54
s_add_u32 s50, s47, 34816
v_mfma_f32_16x16x32_bf16 v[48:51], a[108:111], a[40:43], v[48:51]
s_cmp_eq_u32 s50, 104448
s_cselect_b32 s50, 0, s50
v_mfma_f32_16x16x32_bf16 v[52:55], a[108:111], a[44:47], v[52:55]
s_sub_u32 s48, s50, s47
s_mov_b32 s47, s50
v_mfma_f32_16x16x32_bf16 v[56:59], a[108:111], a[48:51], v[56:59]
v_add_u32 v9, s48, v9
v_add_u32 v10, s48, v10
v_mfma_f32_16x16x32_bf16 v[60:63], a[108:111], a[52:55], v[60:63]
s_add_u32 s40, s40, 128
v_mfma_f32_16x16x32_bf16 v[64:67], a[108:111], a[56:59], v[64:67]
s_and_b32 s40, s40, 2047
s_add_u32 s41, s40, s52
ds_read_b64_tr_b16 a[80:81], v11 offset:0
v_mfma_f32_16x16x32_bf16 v[68:71], a[108:111], a[60:63], v[68:71]
s_add_u32 s42, s41, 65536
v_mfma_f32_16x16x32_bf16 v[72:75], a[108:111], a[64:67], v[72:75]
ds_read_b128 a[0:3], v9 offset:0
v_mfma_f32_16x16x32_bf16 v[76:79], a[108:111], a[68:71], v[76:79]
v_mfma_f32_16x16x32_bf16 v[80:83], a[112:115], a[40:43], v[80:83]
ds_read_b64_tr_b16 a[82:83], v11 offset:512
v_mfma_f32_16x16x32_bf16 v[84:87], a[112:115], a[44:47], v[84:87]
s_add_u32 s38, s38, 32
s_and_b32 s38, s38, 1023
s_mul_i32 s39, s38, 6144
s_mov_b32 m0, s37
v_mfma_f32_16x16x32_bf16 v[88:91], a[112:115], a[48:51], v[88:91]
ds_read_b128 a[4:7], v9 offset:2048
v_mfma_f32_16x16x32_bf16 v[92:95], a[112:115], a[52:55], v[92:95]
ds_read_b64_tr_b16 a[84:85], v12 offset:0
v_mfma_f32_16x16x32_bf16 v[96:99], a[112:115], a[56:59], v[96:99]
v_mfma_f32_16x16x32_bf16 v[100:103], a[112:115], a[60:63], v[100:103]
ds_read_b128 a[8:11], v9 offset:4096
buffer_load_dwordx4 v5, s[12:15], s39 offen offset:0 lds
v_mfma_f32_16x16x32_bf16 v[104:107], a[112:115], a[64:67], v[104:107]
v_mfma_f32_16x16x32_bf16 v[108:111], a[112:115], a[68:71], v[108:111]
ds_read_b64_tr_b16 a[86:87], v12 offset:512
v_mfma_f32_16x16x32_bf16 v[112:115], a[116:119], a[40:43], v[112:115]
v_mfma_f32_16x16x32_bf16 v[116:119], a[116:119], a[44:47], v[116:119]
ds_read_b64_tr_b16 a[88:89], v11 offset:1024
v_mfma_f32_16x16x32_bf16 v[120:123], a[116:119], a[48:51], v[120:123]
buffer_load_dwordx4 v6, s[12:15], s39 offen offset:1024 lds
ds_read_b128 a[12:15], v9 offset:6144
v_mfma_f32_16x16x32_bf16 v[124:127], a[116:119], a[52:55], v[124:127]
v_mfma_f32_16x16x32_bf16 v[128:131], a[116:119], a[56:59], v[128:131]
ds_read_b64_tr_b16 a[90:91], v11 offset:1536
v_mfma_f32_16x16x32_bf16 v[132:135], a[116:119], a[60:63], v[132:135]
v_mfma_f32_16x16x32_bf16 v[136:139], a[116:119], a[64:67], v[136:139]
ds_read_b128 a[16:19], v9 offset:8192
v_mfma_f32_16x16x32_bf16 v[140:143], a[116:119], a[68:71], v[140:143]
buffer_load_dwordx4 v7, s[12:15], s39 offen offset:2048 lds
v_mfma_f32_16x16x32_bf16 v[144:147], a[120:123], a[40:43], v[144:147]
ds_read_b64_tr_b16 a[92:93], v12 offset:1024
v_mfma_f32_16x16x32_bf16 v[148:151], a[120:123], a[44:47], v[148:151]
v_mfma_f32_16x16x32_bf16 v[152:155], a[120:123], a[48:51], v[152:155]
ds_read_b128 a[20:23], v9 offset:10240
v_mfma_f32_16x16x32_bf16 v[156:159], a[120:123], a[52:55], v[156:159]
s_mov_b32 m0, s44
ds_read_b64_tr_b16 a[94:95], v12 offset:1536
v_mfma_f32_16x16x32_bf16 v[160:163], a[120:123], a[56:59], v[160:163]
v_mfma_f32_16x16x32_bf16 v[164:167], a[120:123], a[60:63], v[164:167]
ds_read_b64_tr_b16 a[96:97], v11 offset:2048
v_mfma_f32_16x16x32_bf16 v[168:171], a[120:123], a[64:67], v[168:171]
v_mfma_f32_16x16x32_bf16 v[172:175], a[120:123], a[68:71], v[172:175]
ds_read_b128 a[24:27], v9 offset:12288
v_mfma_f32_16x16x32_bf16 v[176:179], a[40:43], a[124:127], v[176:179]
buffer_load_dwordx4 v1, s[8:11], s41 offen offset:0 lds
v_mfma_f32_16x16x32_bf16 v[180:183], a[44:47], a[124:127], v[180:183]
ds_read_b64_tr_b16 a[98:99], v11 offset:2560
v_mfma_f32_16x16x32_bf16 v[184:187], a[48:51], a[124:127], v[184:187]
ds_read_b128 a[28:31], v9 offset:14336
v_mfma_f32_16x16x32_bf16 v[188:191], a[52:55], a[124:127], v[188:191]
v_mfma_f32_16x16x32_bf16 v[192:195], a[56:59], a[124:127], v[192:195]
ds_read_b64_tr_b16 a[100:101], v12 offset:2048
buffer_load_dwordx4 v2, s[8:11], s41 offen offset:1024 lds
v_mfma_f32_16x16x32_bf16 v[196:199], a[60:63], a[124:127], v[196:199]
v_mfma_f32_16x16x32_bf16 v[200:203], a[64:67], a[124:127], v[200:203]
ds_read_b128 a[32:35], v9 offset:16384
v_mfma_f32_16x16x32_bf16 v[204:207], a[68:71], a[124:127], v[204:207]
v_mfma_f32_16x16x32_bf16 v[208:211], a[40:43], a[128:131], v[208:211]
ds_read_b64_tr_b16 a[102:103], v12 offset:2560
v_mfma_f32_16x16x32_bf16 v[212:215], a[44:47], a[128:131], v[212:215]
buffer_load_dwordx4 v3, s[8:11], s41 offen offset:2048 lds
v_mfma_f32_16x16x32_bf16 v[216:219], a[48:51], a[128:131], v[216:219]
v_mfma_f32_16x16x32_bf16 v[220:223], a[52:55], a[128:131], v[220:223]
v_mfma_f32_16x16x32_bf16 v[224:227], a[56:59], a[128:131], v[224:227]
v_mfma_f32_16x16x32_bf16 v[228:231], a[60:63], a[128:131], v[228:231]
v_mfma_f32_16x16x32_bf16 v[232:235], a[64:67], a[128:131], v[232:235]
buffer_load_dwordx4 v4, s[8:11], s41 offen offset:3072 lds
v_mfma_f32_16x16x32_bf16 v[236:239], a[68:71], a[128:131], v[236:239]
v_mfma_f32_16x16x32_bf16 v[240:243], a[72:75], a[124:127], v[240:243]
v_mfma_f32_16x16x32_bf16 v[244:247], a[72:75], a[128:131], v[244:247]
s_waitcnt vmcnt(15) lgkmcnt(0)
s_barrier
s_add_u32 s33, s33, 1
s_cmp_lt_u32 s33, 8
s_cbranch_scc1 L_loop_qkv1
s_waitcnt vmcnt(0)
s_barrier
v_cvt_pk_bf16_f32 v124, v124, v125
v_cvt_pk_bf16_f32 v120, v120, v121
v_cvt_pk_bf16_f32 v116, v116, v117
v_cvt_pk_bf16_f32 v112, v112, v113
v_cvt_pk_bf16_f32 v56, v56, v57
v_cvt_pk_bf16_f32 v60, v60, v61
v_cvt_pk_bf16_f32 v125, v126, v127
v_cvt_pk_bf16_f32 v121, v122, v123
v_cvt_pk_bf16_f32 v117, v118, v119
v_cvt_pk_bf16_f32 v113, v114, v115
v_cvt_pk_bf16_f32 v57, v58, v59
v_cvt_pk_bf16_f32 v61, v62, v63
v_cvt_pk_bf16_f32 v126, v156, v157
v_cvt_pk_bf16_f32 v127, v158, v159
v_cvt_pk_bf16_f32 v122, v152, v153
v_cvt_pk_bf16_f32 v123, v154, v155
v_cvt_pk_bf16_f32 v118, v148, v149
v_cvt_pk_bf16_f32 v119, v150, v151
v_cvt_pk_bf16_f32 v114, v144, v145
v_cvt_pk_bf16_f32 v115, v146, v147
v_cvt_pk_bf16_f32 v58, v88, v89
v_cvt_pk_bf16_f32 v59, v90, v91
v_cvt_pk_bf16_f32 v62, v92, v93
v_cvt_pk_bf16_f32 v63, v94, v95
v_cvt_pk_bf16_f32 v64, v64, v65
v_cvt_pk_bf16_f32 v68, v68, v69
v_cvt_pk_bf16_f32 v48, v48, v49
v_cvt_pk_bf16_f32 v52, v52, v53
v_cvt_pk_bf16_f32 v65, v66, v67
v_cvt_pk_bf16_f32 v69, v70, v71
v_cvt_pk_bf16_f32 v49, v50, v51
v_cvt_pk_bf16_f32 v53, v54, v55
v_cvt_pk_bf16_f32 v66, v96, v97
v_cvt_pk_bf16_f32 v67, v98, v99
v_cvt_pk_bf16_f32 v70, v100, v101
v_cvt_pk_bf16_f32 v50, v80, v81
v_cvt_pk_bf16_f32 v51, v82, v83
v_cvt_pk_bf16_f32 v54, v84, v85
v_cvt_pk_bf16_f32 v55, v86, v87
v_mfma_f32_16x16x32_bf16 v[80:83], v[112:115], v[56:59], 0
v_mfma_f32_16x16x32_bf16 v[84:87], v[120:123], v[56:59], 0
v_mfma_f32_16x16x32_bf16 v[94:97], v[116:119], v[60:63], 0
v_mfma_f32_16x16x32_bf16 v[98:101], v[124:127], v[60:63], 0
v_cvt_pk_bf16_f32 v72, v72, v73
v_cvt_pk_bf16_f32 v73, v74, v75
v_cvt_pk_bf16_f32 v75, v106, v107
s_lshl_b32 s50, s31, 1
s_add_u32 s50, s50, 1
s_mul_i32 s50, s50, 1474560
v_cndmask_b32 v84, v84, v80, s[56:57]
v_cndmask_b32 v85, v85, v81, s[58:59]
v_cndmask_b32 v86, v86, v82, s[60:61]
v_cndmask_b32 v87, v87, v83, s[62:63]
v_cndmask_b32 v98, v98, v94, s[56:57]
v_cndmask_b32 v99, v99, v95, s[58:59]
v_cndmask_b32 v100, v100, v96, s[60:61]
v_cndmask_b32 v101, v101, v97, s[62:63]
v_pk_fma_f32 v[84:85], v[84:85], s[68:69], v[32:33]
v_pk_fma_f32 v[86:87], v[86:87], s[68:69], v[34:35]
v_pk_fma_f32 v[98:99], v[98:99], s[68:69], v[32:33]
v_pk_fma_f32 v[100:101], v[100:101], s[68:69], v[34:35]
v_max3_f32 v92, v84, v85, v86
v_max3_f32 v106, v98, v99, v100
v_max_f32 v92, v92, v87
v_max_f32 v106, v106, v101
s_lshl_b32 s51, s32, 1
s_add_u32 s51, s51, s30
v_permlane16_swap_b32 v92, v106
v_max_f32 v92, v92, v106
v_mov_b32 v93, v92
s_mul_i32 s51, s51, 10240
s_add_u32 s65, s50, s51
v_permlane32_swap_b32 v93, v92
v_max_f32 v92, v93, v92
v_mov_b32 v93, v92
s_add_u32 s66, s65, 5120
s_lshl_b32 s70, s31, 8
v_permlane16_swap_b32 v93, v92
v_pk_add_f32 v[84:85], v[84:85], v[92:93] op_sel:[0,1] op_sel_hi:[1,1] neg_lo:[0,1] neg_hi:[0,1]
v_pk_add_f32 v[86:87], v[86:87], v[92:93] op_sel:[0,1] op_sel_hi:[1,1] neg_lo:[0,1] neg_hi:[0,1]
v_pk_add_f32 v[98:99], v[98:99], v[92:93] op_sel:[0,0] op_sel_hi:[1,0] neg_lo:[0,1] neg_hi:[0,1]
v_pk_add_f32 v[100:101], v[100:101], v[92:93] op_sel:[0,0] op_sel_hi:[1,0] neg_lo:[0,1] neg_hi:[0,1]
s_lshl_b32 s51, s32, 4
v_cvt_pk_bf16_f32 v76, v76, v77
v_exp_f32 v84, v84
v_exp_f32 v85, v85
v_exp_f32 v86, v86
v_exp_f32 v87, v87
v_exp_f32 v98, v98
v_exp_f32 v99, v99
v_exp_f32 v100, v100
v_exp_f32 v101, v101
s_add_u32 s70, s70, s51
v_cvt_pk_bf16_f32 v74, v104, v105
v_cvt_pk_bf16_f32 v77, v78, v79
s_lshl_b32 s51, s28, 2
v_cvt_pk_bf16_f32 v71, v102, v103
v_cvt_pk_bf16_f32 v78, v108, v109
v_cvt_pk_bf16_f32 v90, v84, v85
v_cvt_pk_bf16_f32 v91, v86, v87
v_cvt_pk_bf16_f32 v104, v98, v99
v_cvt_pk_bf16_f32 v105, v100, v101
s_add_u32 s70, s70, s51
v_cvt_pk_bf16_f32 v79, v110, v111
v_lshrrev_b32 v108, 4, v0
v_and_b32 v88, v90, v40
v_and_b32 v89, v91, v41
v_and_b32 v102, v104, v40
v_and_b32 v103, v105, v41
v_cvt_pk_bf16_f32 v136, v136, v137
v_cvt_pk_bf16_f32 v132, v132, v133
v_add_u32 v108, s70, v108
v_and_b32 v110, 15, v0
v_and_b32 v90, v90, v42
v_and_b32 v91, v91, v43
v_and_b32 v104, v104, v42
v_and_b32 v105, v105, v43
s_lshl_b32 s71, s30, 13
v_cvt_pk_bf16_f32 v137, v138, v139
v_cvt_pk_bf16_f32 v133, v134, v135
v_lshlrev_b32 v109, 11, v108
v_lshlrev_b32 v110, 4, v110
s_mov_b32 s10, 0x400000
v_cvt_pk_bf16_f32 v138, v168, v169
v_cvt_pk_bf16_f32 v135, v166, v167
v_cvt_pk_bf16_f32 v146, v176, v177
v_cvt_pk_bf16_f32 v147, v178, v179
v_cvt_pk_bf16_f32 v156, v180, v181
v_cvt_pk_bf16_f32 v157, v182, v183
v_cvt_pk_bf16_f32 v148, v184, v185
v_cvt_pk_bf16_f32 v149, v186, v187
v_cvt_pk_bf16_f32 v158, v188, v189
v_cvt_pk_bf16_f32 v159, v190, v191
v_add_u32 v109, v109, v110
v_cvt_pk_bf16_f32 v166, v208, v209
v_cvt_pk_bf16_f32 v167, v210, v211
v_cvt_pk_bf16_f32 v4, v212, v213
v_cvt_pk_bf16_f32 v5, v214, v215
v_cvt_pk_bf16_f32 v168, v216, v217
v_cvt_pk_bf16_f32 v169, v218, v219
v_cvt_pk_bf16_f32 v6, v220, v221
v_cvt_pk_bf16_f32 v7, v222, v223
buffer_load_dwordx4 v[176:179], v109, s[8:11], 0 offen offset:0
v_mfma_f32_16x16x32_bf16 v[84:87], v[44:47], v[88:91], 0
v_mfma_f32_16x16x32_bf16 v[98:101], v[44:47], v[102:105], 0
v_cvt_pk_bf16_f32 v128, v128, v129
buffer_load_dwordx4 v[180:183], v109, s[8:11], 0 offen offset:256
v_cvt_pk_bf16_f32 v129, v130, v131
buffer_load_dwordx4 v[184:187], v109, s[8:11], 0 offen offset:512
v_mfma_f32_16x16x32_bf16 v[56:59], v[146:149], v[88:91], 0
v_mfma_f32_16x16x32_bf16 v[60:63], v[156:159], v[102:105], 0
v_cvt_pk_bf16_f32 v130, v160, v161
v_cvt_pk_bf16_f32 v150, v192, v193
v_cvt_pk_bf16_f32 v151, v194, v195
buffer_load_dwordx4 v[188:191], v109, s[8:11], 0 offen offset:768
v_mfma_f32_16x16x32_bf16 v[80:83], v[166:169], v[88:91], 0
v_mfma_f32_16x16x32_bf16 v[94:97], v[4:7], v[102:105], 0
v_cvt_pk_bf16_f32 v160, v196, v197
v_cvt_pk_bf16_f32 v161, v198, v199
buffer_load_dwordx4 v[192:195], v109, s[8:11], 0 offen offset:1024
v_cvt_pk_bf16_f32 v131, v162, v163
v_cvt_pk_bf16_f32 v152, v200, v201
v_cvt_pk_bf16_f32 v153, v202, v203
buffer_load_dwordx4 v[196:199], v109, s[8:11], 0 offen offset:1280
v_cvt_pk_bf16_f32 v162, v204, v205
v_cvt_pk_bf16_f32 v163, v206, v207
buffer_load_dwordx4 v[200:203], v109, s[8:11], 0 offen offset:1536
buffer_load_dwordx4 v[204:207], v109, s[8:11], 0 offen offset:1792
v_cvt_pk_bf16_f32 v140, v140, v141
buffer_load_dwordx4 v[208:211], v110, s[20:23], 0 offen offset:0
v_cvt_pk_bf16_f32 v141, v142, v143
buffer_load_dwordx4 v[212:215], v110, s[20:23], 0 offen offset:256
v_rcp_f32 v84, v84
v_rcp_f32 v98, v98
v_lshlrev_b32 v1, 4, v0
v_cvt_pk_bf16_f32 v143, v174, v175
v_cvt_pk_bf16_f32 v139, v170, v171
buffer_load_dwordx4 v[216:219], v110, s[20:23], 0 offen offset:512
v_add_u32 v174, s71, v1
v_cvt_pk_bf16_f32 v170, v224, v225
v_cvt_pk_bf16_f32 v171, v226, v227
buffer_load_dwordx4 v[220:223], v110, s[20:23], 0 offen offset:768
v_pk_mul_f32 v[56:57], v[56:57], v[84:85] op_sel_hi:[1,0]
v_pk_mul_f32 v[58:59], v[58:59], v[84:85] op_sel_hi:[1,0]
v_pk_mul_f32 v[60:61], v[60:61], v[98:99] op_sel_hi:[1,0]
v_pk_mul_f32 v[62:63], v[62:63], v[98:99] op_sel_hi:[1,0]
v_cvt_pk_bf16_f32 v142, v172, v173
v_cvt_pk_bf16_f32 v8, v228, v229
v_cvt_pk_bf16_f32 v9, v230, v231
buffer_load_dwordx4 v[224:227], v110, s[20:23], 0 offen offset:1024
v_pk_mul_f32 v[80:81], v[80:81], v[84:85] op_sel_hi:[1,0]
v_pk_mul_f32 v[82:83], v[82:83], v[84:85] op_sel_hi:[1,0]
v_pk_mul_f32 v[94:95], v[94:95], v[98:99] op_sel_hi:[1,0]
v_pk_mul_f32 v[96:97], v[96:97], v[98:99] op_sel_hi:[1,0]
v_lshrrev_b32 v1, 3, v0
v_cvt_pk_bf16_f32 v88, v56, v57
v_cvt_pk_bf16_f32 v89, v58, v59
v_cvt_pk_bf16_f32 v90, v60, v61
v_cvt_pk_bf16_f32 v91, v62, v63
v_cvt_pk_bf16_f32 v172, v232, v233
v_cvt_pk_bf16_f32 v173, v234, v235
buffer_load_dwordx4 v[228:231], v110, s[20:23], 0 offen offset:1280
v_lshlrev_b32 v1, 2, v1
s_mov_b32 s50, 572662289
v_cvt_pk_bf16_f32 v102, v80, v81
v_cvt_pk_bf16_f32 v103, v82, v83
v_cvt_pk_bf16_f32 v104, v94, v95
v_cvt_pk_bf16_f32 v105, v96, v97
v_lshlrev_b32 v175, 3, v0
v_cvt_pk_bf16_f32 v10, v236, v237
v_cvt_pk_bf16_f32 v11, v238, v239
v_cvt_pk_bf16_f32 v240, v240, v241
v_lshlrev_b32 v111, 4, v0
buffer_load_dwordx4 v[232:235], v110, s[20:23], 0 offen offset:1536
v_lshrrev_b32 v109, 4, v108
v_bfe_u32 v1, s50, v1, 4
v_add_u32 v175, s71, v175
v_cvt_pk_bf16_f32 v241, v242, v243
v_cvt_pk_bf16_f32 v244, v244, v245
buffer_load_dwordx4 v[236:239], v110, s[20:23], 0 offen offset:1792
v_and_b32 v108, 15, v108
v_lshl_add_u32 v1, v1, 7, v111
v_permlane16_swap_b32 v88, v90
v_permlane16_swap_b32 v89, v91
ds_write_b64 v175, v[240:241] offset:4096
v_cvt_pk_bf16_f32 v245, v246, v247
v_lshlrev_b32 v109, 7, v109
v_lshlrev_b32 v108, 2, v108
buffer_store_dwordx4 v[88:91], v1, s[16:19], s65 offen offset:1024 sc1
v_permlane16_swap_b32 v102, v104
v_permlane16_swap_b32 v103, v105
v_cvt_pk_bf16_f32 v134, v164, v165
ds_write_b64 v175, v[244:245] offset:5120
v_add_u32 v108, v108, v109
buffer_store_dwordx4 v[102:105], v1, s[16:19], s66 offen offset:1024 sc1
s_waitcnt lgkmcnt(0)
s_barrier
v_mfma_f32_16x16x32_bf16 v[12:15], v[120:123], v[64:67], 0
v_mfma_f32_16x16x32_bf16 v[16:19], v[128:131], v[64:67], 0
v_mfma_f32_16x16x32_bf16 v[248:251], v[124:127], v[68:71], 0
v_mfma_f32_16x16x32_bf16 v[252:255], v[132:135], v[68:71], 0
v_mfma_f32_16x16x32_bf16 v[80:83], v[128:131], v[72:75], 0
v_mfma_f32_16x16x32_bf16 v[84:87], v[136:139], v[72:75], 0
v_mfma_f32_16x16x32_bf16 v[94:97], v[132:135], v[76:79], 0
v_mfma_f32_16x16x32_bf16 v[98:101], v[140:143], v[76:79], 0
v_lshrrev_b32 v1, 3, v0
v_lshlrev_b32 v1, 2, v1
v_cndmask_b32 v16, v16, v12, s[56:57]
v_cndmask_b32 v17, v17, v13, s[58:59]
v_cndmask_b32 v18, v18, v14, s[60:61]
v_cndmask_b32 v19, v19, v15, s[62:63]
v_cndmask_b32 v252, v252, v248, s[56:57]
v_cndmask_b32 v253, v253, v249, s[58:59]
v_cndmask_b32 v254, v254, v250, s[60:61]
v_cndmask_b32 v255, v255, v251, s[62:63]
v_pk_fma_f32 v[16:17], v[16:17], s[68:69], v[32:33]
v_pk_fma_f32 v[18:19], v[18:19], s[68:69], v[34:35]
v_pk_fma_f32 v[252:253], v[252:253], s[68:69], v[32:33]
v_pk_fma_f32 v[254:255], v[254:255], s[68:69], v[34:35]
v_max3_f32 v24, v16, v17, v18
v_max3_f32 v30, v252, v253, v254
v_max_f32 v24, v24, v19
v_max_f32 v30, v30, v255
v_cndmask_b32 v84, v84, v80, s[56:57]
v_cndmask_b32 v85, v85, v81, s[58:59]
v_permlane16_swap_b32 v24, v30
v_cndmask_b32 v86, v86, v82, s[60:61]
v_cndmask_b32 v87, v87, v83, s[62:63]
v_cndmask_b32 v98, v98, v94, s[56:57]
v_cndmask_b32 v99, v99, v95, s[58:59]
v_cndmask_b32 v100, v100, v96, s[60:61]
v_cndmask_b32 v101, v101, v97, s[62:63]
v_max_f32 v24, v24, v30
v_pk_fma_f32 v[84:85], v[84:85], s[68:69], v[32:33]
v_pk_fma_f32 v[86:87], v[86:87], s[68:69], v[34:35]
v_pk_fma_f32 v[98:99], v[98:99], s[68:69], v[32:33]
v_pk_fma_f32 v[100:101], v[100:101], s[68:69], v[34:35]
v_mov_b32 v25, v24
v_max3_f32 v92, v84, v85, v86
v_max3_f32 v106, v98, v99, v100
v_max_f32 v92, v92, v87
v_max_f32 v106, v106, v101
v_permlane32_swap_b32 v25, v24
v_max_f32 v24, v25, v24
v_permlane16_swap_b32 v92, v106
v_mov_b32 v25, v24
v_max_f32 v92, v92, v106
v_mov_b32 v93, v92
v_permlane16_swap_b32 v25, v24
v_pk_add_f32 v[16:17], v[16:17], v[24:25] op_sel:[0,1] op_sel_hi:[1,1] neg_lo:[0,1] neg_hi:[0,1]
v_pk_add_f32 v[18:19], v[18:19], v[24:25] op_sel:[0,1] op_sel_hi:[1,1] neg_lo:[0,1] neg_hi:[0,1]
v_pk_add_f32 v[252:253], v[252:253], v[24:25] op_sel:[0,0] op_sel_hi:[1,0] neg_lo:[0,1] neg_hi:[0,1]
v_pk_add_f32 v[254:255], v[254:255], v[24:25] op_sel:[0,0] op_sel_hi:[1,0] neg_lo:[0,1] neg_hi:[0,1]
v_permlane32_swap_b32 v93, v92
v_exp_f32 v16, v16
v_exp_f32 v17, v17
v_exp_f32 v18, v18
v_exp_f32 v19, v19
v_exp_f32 v252, v252
v_exp_f32 v253, v253
v_exp_f32 v254, v254
v_exp_f32 v255, v255
v_max_f32 v92, v93, v92
v_mov_b32 v93, v92
v_cvt_pk_bf16_f32 v22, v16, v17
v_cvt_pk_bf16_f32 v23, v18, v19
v_cvt_pk_bf16_f32 v28, v252, v253
v_cvt_pk_bf16_f32 v29, v254, v255
v_and_b32 v20, v22, v40
v_and_b32 v21, v23, v41
v_and_b32 v26, v28, v40
v_and_b32 v27, v29, v41
v_and_b32 v22, v22, v42
v_and_b32 v23, v23, v43
v_and_b32 v28, v28, v42
v_and_b32 v29, v29, v43
v_permlane16_swap_b32 v93, v92
v_pk_add_f32 v[84:85], v[84:85], v[92:93] op_sel:[0,1] op_sel_hi:[1,1] neg_lo:[0,1] neg_hi:[0,1]
v_pk_add_f32 v[86:87], v[86:87], v[92:93] op_sel:[0,1] op_sel_hi:[1,1] neg_lo:[0,1] neg_hi:[0,1]
v_pk_add_f32 v[98:99], v[98:99], v[92:93] op_sel:[0,0] op_sel_hi:[1,0] neg_lo:[0,1] neg_hi:[0,1]
v_pk_add_f32 v[100:101], v[100:101], v[92:93] op_sel:[0,0] op_sel_hi:[1,0] neg_lo:[0,1] neg_hi:[0,1]
v_exp_f32 v84, v84
v_exp_f32 v85, v85
v_exp_f32 v86, v86
v_exp_f32 v87, v87
v_exp_f32 v98, v98
v_exp_f32 v99, v99
v_exp_f32 v100, v100
v_exp_f32 v101, v101
v_mfma_f32_16x16x32_bf16 v[16:19], v[44:47], v[20:23], 0
v_mfma_f32_16x16x32_bf16 v[252:255], v[44:47], v[26:29], 0
v_cvt_pk_bf16_f32 v90, v84, v85
v_cvt_pk_bf16_f32 v91, v86, v87
v_cvt_pk_bf16_f32 v104, v98, v99
v_cvt_pk_bf16_f32 v105, v100, v101
v_mfma_f32_16x16x32_bf16 v[64:67], v[148:151], v[20:23], 0
v_mfma_f32_16x16x32_bf16 v[68:71], v[158:161], v[26:29], 0
v_and_b32 v88, v90, v40
v_and_b32 v89, v91, v41
v_and_b32 v102, v104, v40
v_and_b32 v103, v105, v41
v_mfma_f32_16x16x32_bf16 v[12:15], v[168:171], v[20:23], 0
v_mfma_f32_16x16x32_bf16 v[248:251], v[6:9], v[26:29], 0
v_and_b32 v90, v90, v42
v_and_b32 v91, v91, v43
v_and_b32 v104, v104, v42
v_and_b32 v105, v105, v43
v_mfma_f32_16x16x32_bf16 v[84:87], v[44:47], v[88:91], 0
v_mfma_f32_16x16x32_bf16 v[72:75], v[150:153], v[88:91], 0
v_mfma_f32_16x16x32_bf16 v[98:101], v[44:47], v[102:105], 0
v_mfma_f32_16x16x32_bf16 v[76:79], v[160:163], v[102:105], 0
v_rcp_f32 v16, v16
v_rcp_f32 v252, v252
v_mfma_f32_16x16x32_bf16 v[80:83], v[170:173], v[88:91], 0
v_mfma_f32_16x16x32_bf16 v[94:97], v[8:11], v[102:105], 0
v_pk_mul_f32 v[64:65], v[64:65], v[16:17] op_sel_hi:[1,0]
v_pk_mul_f32 v[66:67], v[66:67], v[16:17] op_sel_hi:[1,0]
v_pk_mul_f32 v[68:69], v[68:69], v[252:253] op_sel_hi:[1,0]
v_pk_mul_f32 v[70:71], v[70:71], v[252:253] op_sel_hi:[1,0]
v_pk_mul_f32 v[12:13], v[12:13], v[16:17] op_sel_hi:[1,0]
v_pk_mul_f32 v[14:15], v[14:15], v[16:17] op_sel_hi:[1,0]
v_pk_mul_f32 v[248:249], v[248:249], v[252:253] op_sel_hi:[1,0]
v_pk_mul_f32 v[250:251], v[250:251], v[252:253] op_sel_hi:[1,0]
v_cvt_pk_bf16_f32 v20, v64, v65
v_cvt_pk_bf16_f32 v21, v66, v67
v_cvt_pk_bf16_f32 v22, v68, v69
v_cvt_pk_bf16_f32 v23, v70, v71
s_mov_b32 s50, 858993458
v_cvt_pk_bf16_f32 v26, v12, v13
v_cvt_pk_bf16_f32 v27, v14, v15
v_cvt_pk_bf16_f32 v28, v248, v249
v_cvt_pk_bf16_f32 v29, v250, v251
v_bfe_u32 v1, s50, v1, 4
v_lshl_add_u32 v1, v1, 7, v111
v_permlane16_swap_b32 v20, v22
v_permlane16_swap_b32 v21, v23
v_rcp_f32 v84, v84
v_rcp_f32 v98, v98
buffer_store_dwordx4 v[20:23], v1, s[16:19], s65 offen offset:2048 sc1
v_permlane16_swap_b32 v26, v28
v_permlane16_swap_b32 v27, v29
buffer_store_dwordx4 v[26:29], v1, s[16:19], s66 offen offset:2048 sc1
v_pk_mul_f32 v[72:73], v[72:73], v[84:85] op_sel_hi:[1,0]
v_pk_mul_f32 v[74:75], v[74:75], v[84:85] op_sel_hi:[1,0]
v_pk_mul_f32 v[76:77], v[76:77], v[98:99] op_sel_hi:[1,0]
v_pk_mul_f32 v[78:79], v[78:79], v[98:99] op_sel_hi:[1,0]
ds_read_b128 v[240:243], v174 offset:0
v_pk_mul_f32 v[80:81], v[80:81], v[84:85] op_sel_hi:[1,0]
v_pk_mul_f32 v[82:83], v[82:83], v[84:85] op_sel_hi:[1,0]
v_pk_mul_f32 v[94:95], v[94:95], v[98:99] op_sel_hi:[1,0]
v_pk_mul_f32 v[96:97], v[96:97], v[98:99] op_sel_hi:[1,0]
v_lshrrev_b32 v1, 3, v0
v_cvt_pk_bf16_f32 v88, v72, v73
v_cvt_pk_bf16_f32 v89, v74, v75
v_cvt_pk_bf16_f32 v90, v76, v77
v_cvt_pk_bf16_f32 v91, v78, v79
ds_read_b128 v[244:247], v174 offset:1024
v_lshlrev_b32 v1, 2, v1
s_mov_b32 s50, 1413760068
v_cvt_pk_bf16_f32 v102, v80, v81
v_cvt_pk_bf16_f32 v103, v82, v83
v_cvt_pk_bf16_f32 v104, v94, v95
v_cvt_pk_bf16_f32 v105, v96, v97
ds_read_b64 v[144:145], v175 offset:2048
v_bfe_u32 v1, s50, v1, 4
ds_read_b64 v[154:155], v175 offset:2560
v_lshl_add_u32 v1, v1, 7, v111
v_permlane16_swap_b32 v88, v90
v_permlane16_swap_b32 v89, v91
ds_read_b64 v[164:165], v175 offset:3072
buffer_store_dwordx4 v[88:91], v1, s[16:19], s65 offen offset:3072 sc1
v_permlane16_swap_b32 v102, v104
v_permlane16_swap_b32 v103, v105
ds_read_b64 v[2:3], v175 offset:3584
buffer_store_dwordx4 v[102:105], v1, s[16:19], s66 offen offset:3072 sc1
s_waitcnt vmcnt(6) lgkmcnt(0)
v_mfma_f32_16x16x32_bf16 v[12:15], v[240:243], v[48:51], 0
v_mfma_f32_16x16x32_bf16 v[16:19], v[112:115], v[48:51], 0
v_mfma_f32_16x16x32_bf16 v[248:251], v[244:247], v[52:55], 0
v_mfma_f32_16x16x32_bf16 v[252:255], v[116:119], v[52:55], 0
v_mov_b32 v80, 0
v_mov_b32 v81, 0
v_mov_b32 v82, 0
v_mov_b32 v83, 0
v_dot2c_f32_bf16 v80, v176, v208
v_dot2c_f32_bf16 v81, v177, v209
v_cndmask_b32 v16, v16, v12, s[56:57]
v_cndmask_b32 v17, v17, v13, s[58:59]
v_cndmask_b32 v18, v18, v14, s[60:61]
v_cndmask_b32 v19, v19, v15, s[62:63]
v_cndmask_b32 v252, v252, v248, s[56:57]
v_cndmask_b32 v253, v253, v249, s[58:59]
v_cndmask_b32 v254, v254, v250, s[60:61]
v_cndmask_b32 v255, v255, v251, s[62:63]
v_pk_fma_f32 v[16:17], v[16:17], s[68:69], v[36:37]
v_pk_fma_f32 v[18:19], v[18:19], s[68:69], v[38:39]
v_pk_fma_f32 v[252:253], v[252:253], s[68:69], v[36:37]
v_pk_fma_f32 v[254:255], v[254:255], s[68:69], v[38:39]
v_max3_f32 v24, v16, v17, v18
v_max3_f32 v30, v252, v253, v254
v_max_f32 v24, v24, v19
v_max_f32 v30, v30, v255
v_dot2c_f32_bf16 v82, v178, v210
v_dot2c_f32_bf16 v83, v179, v211
v_permlane16_swap_b32 v24, v30
v_max_f32 v24, v24, v30
v_mov_b32 v25, v24
v_dot2c_f32_bf16 v80, v180, v212
v_dot2c_f32_bf16 v81, v181, v213
v_dot2c_f32_bf16 v82, v182, v214
v_dot2c_f32_bf16 v83, v183, v215
v_dot2c_f32_bf16 v80, v184, v216
v_dot2c_f32_bf16 v81, v185, v217
v_dot2c_f32_bf16 v82, v186, v218
v_dot2c_f32_bf16 v83, v187, v219
v_permlane32_swap_b32 v25, v24
v_dot2c_f32_bf16 v80, v188, v220
v_dot2c_f32_bf16 v81, v189, v221
v_dot2c_f32_bf16 v82, v190, v222
v_dot2c_f32_bf16 v83, v191, v223
v_max_f32 v24, v25, v24
v_dot2c_f32_bf16 v80, v192, v224
v_dot2c_f32_bf16 v81, v193, v225
v_dot2c_f32_bf16 v82, v194, v226
v_dot2c_f32_bf16 v83, v195, v227
v_mov_b32 v25, v24
v_dot2c_f32_bf16 v80, v196, v228
v_dot2c_f32_bf16 v81, v197, v229
v_dot2c_f32_bf16 v82, v198, v230
v_dot2c_f32_bf16 v83, v199, v231
v_dot2c_f32_bf16 v80, v200, v232
v_dot2c_f32_bf16 v81, v201, v233
v_dot2c_f32_bf16 v82, v202, v234
v_dot2c_f32_bf16 v83, v203, v235
v_dot2c_f32_bf16 v80, v204, v236
v_dot2c_f32_bf16 v81, v205, v237
v_dot2c_f32_bf16 v82, v206, v238
v_dot2c_f32_bf16 v83, v207, v239
v_permlane16_swap_b32 v25, v24
v_pk_add_f32 v[16:17], v[16:17], v[24:25] op_sel:[0,1] op_sel_hi:[1,1] neg_lo:[0,1] neg_hi:[0,1]
v_pk_add_f32 v[18:19], v[18:19], v[24:25] op_sel:[0,1] op_sel_hi:[1,1] neg_lo:[0,1] neg_hi:[0,1]
v_pk_add_f32 v[252:253], v[252:253], v[24:25] op_sel:[0,0] op_sel_hi:[1,0] neg_lo:[0,1] neg_hi:[0,1]
v_pk_add_f32 v[254:255], v[254:255], v[24:25] op_sel:[0,0] op_sel_hi:[1,0] neg_lo:[0,1] neg_hi:[0,1]
v_exp_f32 v16, v16
v_exp_f32 v17, v17
v_exp_f32 v18, v18
v_exp_f32 v19, v19
v_exp_f32 v252, v252
v_exp_f32 v253, v253
v_exp_f32 v254, v254
v_exp_f32 v255, v255
v_add_f32 v80, v80, v81
v_add_f32 v82, v82, v83
v_cvt_pk_bf16_f32 v22, v16, v17
v_cvt_pk_bf16_f32 v23, v18, v19
v_cvt_pk_bf16_f32 v28, v252, v253
v_cvt_pk_bf16_f32 v29, v254, v255
v_add_f32 v80, v80, v82
v_and_b32 v20, v22, v40
v_and_b32 v21, v23, v41
v_and_b32 v26, v28, v40
v_and_b32 v27, v29, v41
v_and_b32 v22, v22, v42
v_and_b32 v23, v23, v43
v_and_b32 v28, v28, v42
v_and_b32 v29, v29, v43
v_add_f32_dpp v80, v80, v80 row_ror:8 row_mask:0xf bank_mask:0xf
v_mfma_f32_16x16x32_bf16 v[16:19], v[44:47], v[20:23], 0
v_mfma_f32_16x16x32_bf16 v[252:255], v[44:47], v[26:29], 0
v_add_f32_dpp v80, v80, v80 row_ror:4 row_mask:0xf bank_mask:0xf
v_mfma_f32_16x16x32_bf16 v[48:51], v[144:147], v[20:23], 0
v_mfma_f32_16x16x32_bf16 v[52:55], v[154:157], v[26:29], 0
v_mfma_f32_16x16x32_bf16 v[12:15], v[164:167], v[20:23], 0
v_mfma_f32_16x16x32_bf16 v[248:251], v[2:5], v[26:29], 0
v_add_f32_dpp v80, v80, v80 row_ror:2 row_mask:0xf bank_mask:0xf
v_lshrrev_b32 v1, 3, v0
v_rcp_f32 v16, v16
v_add_f32_dpp v80, v80, v80 row_ror:1 row_mask:0xf bank_mask:0xf
v_cvt_pk_bf16_f32 v80, v80, v80
v_rcp_f32 v252, v252
v_lshlrev_b32 v80, 16, v80
v_mul_f32 v80, 0xbfb8aa3b, v80
v_pk_mul_f32 v[48:49], v[48:49], v[16:17] op_sel_hi:[1,0]
v_pk_mul_f32 v[50:51], v[50:51], v[16:17] op_sel_hi:[1,0]
v_pk_mul_f32 v[52:53], v[52:53], v[252:253] op_sel_hi:[1,0]
v_pk_mul_f32 v[54:55], v[54:55], v[252:253] op_sel_hi:[1,0]
v_exp_f32 v80, v80
v_pk_mul_f32 v[12:13], v[12:13], v[16:17] op_sel_hi:[1,0]
v_pk_mul_f32 v[14:15], v[14:15], v[16:17] op_sel_hi:[1,0]
v_pk_mul_f32 v[248:249], v[248:249], v[252:253] op_sel_hi:[1,0]
v_pk_mul_f32 v[250:251], v[250:251], v[252:253] op_sel_hi:[1,0]
v_cvt_pk_bf16_f32 v20, v48, v49
v_cvt_pk_bf16_f32 v21, v50, v51
v_cvt_pk_bf16_f32 v22, v52, v53
v_cvt_pk_bf16_f32 v23, v54, v55
v_lshlrev_b32 v1, 2, v1
s_mov_b32 s50, 286330880
v_cvt_pk_bf16_f32 v26, v12, v13
v_cvt_pk_bf16_f32 v27, v14, v15
v_cvt_pk_bf16_f32 v28, v248, v249
v_cvt_pk_bf16_f32 v29, v250, v251
v_add_f32 v80, 1.0, v80
v_bfe_u32 v1, s50, v1, 4
v_rcp_f32 v80, v80
v_lshl_add_u32 v1, v1, 7, v111
v_permlane16_swap_b32 v20, v22
v_permlane16_swap_b32 v21, v23
buffer_store_dwordx4 v[20:23], v1, s[16:19], s65 offen offset:0 sc1
v_permlane16_swap_b32 v26, v28
v_permlane16_swap_b32 v27, v29
v_cvt_pk_bf16_f32 v80, v80, v80
v_and_b32 v81, 15, v0
buffer_store_dwordx4 v[26:29], v1, s[16:19], s66 offen offset:0 sc1
v_lshlrev_b32 v80, 16, v80
v_cmp_eq_u32 vcc, 0, v81
s_mov_b32 s50, 23592960
s_and_saveexec_b64 s[72:73], vcc
buffer_store_dword v80, v108, s[16:19], s50 offen sc1
s_mov_b64 exec, s[72:73]
s_and_b32 s41, s32, 7
s_cmp_eq_u32 s41, 3
s_cselect_b32 s41, 1024, 0
s_add_u32 s41, s41, 23625728
s_mov_b32 s52, 0
s_branch L_p3_entry
L_w1:
s_mul_i32 s50, s32, 224
s_and_b32 s51, s32, 1
s_lshl_b32 s68, s51, 5
s_add_u32 s68, s68, s50
s_cmp_eq_u32 s51, 1
s_cselect_b32 s69, 0, 192
s_add_u32 s69, s69, s50
s_lshl_b32 s65, s68, 1
s_mov_b32 s40, 0
v_lshrrev_b32 v14, 3, v0
v_and_b32 v15, 7, v0
v_and_b32 v16, 6, v14
v_xor_b32 v16, v15, v16
v_lshlrev_b32 v16, 4, v16
v_lshlrev_b32 v17, 12, v14
v_add_u32 v17, v17, v16
s_lshl_b32 s50, s28, 17
v_add_u32 v17, s50, v17
v_add_u32 v1, 0, v17
v_add_u32 v2, 31744, v17
v_add_u32 v3, 0, v17
v_add_u32 v4, 31744, v17
s_lshl_b32 s53, s28, 13
s_add_u32 s53, s53, 61440
s_lshl_b32 s52, s31, 19
s_lshl_b32 s54, s28, 10
s_add_u32 s54, s54, 49152
v_lshrrev_b32 v31, 4, v0
v_lshlrev_b32 v31, 3, v31
s_lshl_b32 s50, s30, 6
s_add_u32 s70, s50, s65
s_lshl_b32 s51, s30, 5
s_lshl_b32 s50, s69, 1
s_add_u32 s67, s51, s50
s_add_u32 s41, s40, s52
s_add_u32 s42, s41, 65536
s_mul_i32 s43, s40, 3584
s_mov_b32 s47, 0
s_add_u32 s44, s47, s53
s_add_u32 s45, s44, 4096
s_lshr_b32 s50, s47, 3
s_add_u32 s46, s50, s54
s_waitcnt lgkmcnt(0)
s_mov_b32 s100, s20
s_mov_b32 s101, s21
s_mov_b32 s16, s22
s_mov_b32 s17, s23
s_mov_b32 s18, 32112640
s_mov_b32 s19, 0x00020000
s_mov_b32 s20, s26
s_mov_b32 s21, s27
s_mov_b32 s22, 7168
s_mov_b32 s23, 0x00020000
s_mov_b32 s8, s4
s_mov_b32 s9, s5
s_mov_b32 s10, 4194304
s_mov_b32 s11, 0x00020000
buffer_load_dwordx2 v[40:41], v31, s[20:23], s70 offen offset:0
buffer_load_dwordx2 v[42:43], v31, s[20:23], s70 offen offset:32
buffer_load_dwordx2 v[44:45], v31, s[20:23], s70 offen offset:128
buffer_load_dwordx2 v[46:47], v31, s[20:23], s70 offen offset:160
buffer_load_dwordx2 v[48:49], v31, s[20:23], s70 offen offset:256
buffer_load_dwordx2 v[50:51], v31, s[20:23], s70 offen offset:288
buffer_load_dwordx2 v[52:53], v31, s[20:23], s67 offen
s_mov_b32 m0, s44
s_nop 0
buffer_load_dwordx4 v1, s[8:11], s41 offen offset:0 lds
buffer_load_dwordx4 v2, s[8:11], s41 offen offset:1024 lds
buffer_load_dwordx4 v3, s[8:11], s41 offen offset:2048 lds
buffer_load_dwordx4 v4, s[8:11], s41 offen offset:3072 lds
s_mov_b32 m0, s45
s_nop 0
buffer_load_dwordx4 v1, s[8:11], s42 offen offset:0 lds
buffer_load_dwordx4 v2, s[8:11], s42 offen offset:1024 lds
buffer_load_dwordx4 v3, s[8:11], s42 offen offset:2048 lds
buffer_load_dwordx4 v4, s[8:11], s42 offen offset:3072 lds
s_sub_u32 s12, s24, 4096
s_subb_u32 s13, s25, 0
s_mov_b32 s14, 7344128
s_mov_b32 s15, 0x00020000
v_lshrrev_b32 v25, 2, v0
v_and_b32 v26, 3, v0
v_lshrrev_b32 v27, 3, v25
v_lshlrev_b32 v27, 1, v27
v_xor_b32 v26, v26, v27
v_lshlrev_b32 v26, 4, v26
s_lshl_b32 s50, s28, 4
v_add_u32 v25, s50, v25
v_mul_u32_u24 v25, 7168, v25
v_add_u32 v25, v25, v26
s_lshl_b32 s50, s69, 1
s_add_u32 s50, s50, 4096
v_add_u32 v8, s50, v25
s_mov_b32 m0, s46
s_nop 0
buffer_load_dwordx4 v8, s[12:15], s43 offen lds
s_and_b32 s50, s28, 1
s_lshl_b32 s50, s50, 2
v_and_b32 v18, 2, v14
v_or_b32 v18, s50, v18
v_xor_b32 v18, v15, v18
v_lshlrev_b32 v18, 4, v18
s_lshl_b32 s50, s28, 3
v_add_u32 v19, s50, v14
v_mul_u32_u24 v19, 7168, v19
v_add_u32 v19, v19, v18
s_add_u32 s50, s65, 4096
v_add_u32 v5, s50, v19
s_add_u32 s50, s65, 3200
v_add_u32 v6, s50, v19
s_add_u32 s50, s65, 2304
v_add_u32 v7, s50, v19
s_mul_i32 s34, s28, 3072
s_mul_i32 s35, s28, 3072
s_add_u32 s35, s35, 12288
s_mul_i32 s36, s28, 3072
s_add_u32 s36, s36, 24576
s_mul_i32 s37, s28, 3072
s_add_u32 s37, s37, 36864
s_lshr_b32 s38, s40, 1
s_mul_i32 s39, s38, 7168
s_mov_b32 m0, s34
s_nop 0
buffer_load_dwordx4 v5, s[12:15], s39 offen offset:0 lds
buffer_load_dwordx4 v6, s[12:15], s39 offen offset:1024 lds
buffer_load_dwordx4 v7, s[12:15], s39 offen offset:2048 lds
s_add_u32 s38, s38, 32
s_and_b32 s38, s38, 1023
s_mul_i32 s39, s38, 7168
s_mov_b32 m0, s35
s_nop 0
buffer_load_dwordx4 v5, s[12:15], s39 offen offset:0 lds
buffer_load_dwordx4 v6, s[12:15], s39 offen offset:1024 lds
buffer_load_dwordx4 v7, s[12:15], s39 offen offset:2048 lds
s_waitcnt vmcnt(15)
s_add_u32 s40, s40, 128
s_and_b32 s40, s40, 2047
s_add_u32 s41, s40, s52
s_add_u32 s42, s41, 65536
s_mul_i32 s43, s40, 3584
s_mov_b32 s47, 32768
s_add_u32 s44, s47, s53
s_add_u32 s45, s44, 4096
s_lshr_b32 s50, s47, 3
s_add_u32 s46, s50, s54
s_mov_b32 m0, s44
s_nop 0
buffer_load_dwordx4 v1, s[8:11], s41 offen offset:0 lds
v_and_b32 v21, 15, v0
v_lshrrev_b32 v20, 4, v0
v_and_b32 v22, 6, v21
v_xor_b32 v22, v20, v22
v_lshlrev_b32 v22, 4, v22
v_lshlrev_b32 v23, 7, v21
v_add_u32 v22, v22, v23
s_lshl_b32 s51, s29, 14
s_add_u32 s51, s51, 61440
v_add_u32 v9, s51, v22
v_xor_b32 v10, 64, v9
v_lshrrev_b32 v14, 2, v0
v_and_b32 v14, 3, v14
v_and_b32 v15, 3, v0
v_lshrrev_b32 v16, 1, v15
v_and_b32 v17, 2, v14
v_and_b32 v18, 1, v20
buffer_load_dwordx4 v2, s[8:11], s41 offen offset:1024 lds
v_lshlrev_b32 v19, 2, v18
v_or_b32 v17, v17, v19
v_mul_u32_u24 v19, 3072, v20
v_lshlrev_b32 v23, 7, v14
v_add_u32 v19, v19, v23
v_and_b32 v23, 1, v15
v_lshlrev_b32 v23, 3, v23
v_add_u32 v19, v19, v23
s_lshl_b32 s51, s30, 2
s_add_u32 s51, s51, 0
v_or_b32 v23, s51, v16
v_xor_b32 v23, v23, v17
v_lshlrev_b32 v23, 4, v23
v_add_u32 v11, v19, v23
s_lshl_b32 s51, s30, 2
s_add_u32 s51, s51, 2
v_or_b32 v23, s51, v16
buffer_load_dwordx4 v3, s[8:11], s41 offen offset:2048 lds
v_xor_b32 v23, v23, v17
v_lshlrev_b32 v23, 4, v23
v_add_u32 v12, v19, v23
v_lshrrev_b32 v25, 1, v20
v_lshlrev_b32 v25, 10, v25
v_lshlrev_b32 v26, 3, v18
v_add_u32 v26, v26, v14
v_lshlrev_b32 v26, 6, v26
v_add_u32 v25, v25, v26
s_lshl_b32 s51, s30, 1
v_or_b32 v26, s51, v16
v_lshlrev_b32 v27, 1, v18
v_xor_b32 v26, v26, v27
v_lshlrev_b32 v26, 4, v26
v_add_u32 v25, v25, v26
v_and_b32 v26, 1, v15
v_lshlrev_b32 v26, 3, v26
buffer_load_dwordx4 v4, s[8:11], s41 offen offset:3072 lds
v_add_u32 v25, v25, v26
v_add_u32 v13, 49152, v25
s_mov_b32 s92, s72
s_mov_b32 s93, s73
s_mov_b32 s94, 2097152
s_mov_b32 s95, 0x00020000
s_mov_b32 s96, s60
s_mov_b32 s97, s61
s_mov_b32 s98, 7340032
s_mov_b32 s99, 0x00020000
s_lshl_b32 s51, s2, 2
s_add_u32 s51, s51, s28
s_mul_i32 s71, s51, 7168
v_lshlrev_b32 v30, 7, v0
v_mov_b32 v28, 0x7ff00000
v_cmp_gt_u32 vcc, 56, v0
v_lshlrev_b32 v29, 7, v0
s_add_u32 s38, s38, 32
s_and_b32 s38, s38, 1023
s_mul_i32 s39, s38, 7168
s_mov_b32 m0, s36
s_nop 0
buffer_load_dwordx4 v5, s[12:15], s39 offen offset:0 lds
s_lshl_b32 s55, s51, 11
v_cndmask_b32 v30, v28, v30, vcc
v_cmp_gt_u32 vcc, 16, v0
s_nop 1
v_cndmask_b32 v29, v28, v29, vcc
v_lshlrev_b32 v252, 16, v52
v_and_b32 v253, 0xffff0000, v52
v_lshlrev_b32 v254, 16, v53
v_and_b32 v255, 0xffff0000, v53
v_lshlrev_b32 v220, 16, v50
v_and_b32 v221, 0xffff0000, v50
v_lshlrev_b32 v222, 16, v51
v_and_b32 v223, 0xffff0000, v51
v_lshlrev_b32 v188, 16, v48
v_and_b32 v189, 0xffff0000, v48
v_lshlrev_b32 v190, 16, v49
v_and_b32 v191, 0xffff0000, v49
buffer_load_dwordx4 v6, s[12:15], s39 offen offset:1024 lds
v_lshlrev_b32 v156, 16, v46
v_and_b32 v157, 0xffff0000, v46
v_lshlrev_b32 v158, 16, v47
v_and_b32 v159, 0xffff0000, v47
v_lshlrev_b32 v124, 16, v44
v_and_b32 v125, 0xffff0000, v44
v_lshlrev_b32 v126, 16, v45
v_and_b32 v127, 0xffff0000, v45
v_lshlrev_b32 v92, 16, v42
v_and_b32 v93, 0xffff0000, v42
v_lshlrev_b32 v94, 16, v43
v_and_b32 v95, 0xffff0000, v43
v_lshlrev_b32 v60, 16, v40
v_and_b32 v61, 0xffff0000, v40
v_lshlrev_b32 v62, 16, v41
v_and_b32 v63, 0xffff0000, v41
v_mov_b64 v[32:33], v[60:61]
buffer_load_dwordx4 v7, s[12:15], s39 offen offset:2048 lds
v_mov_b64 v[34:35], v[62:63]
v_mov_b64 v[36:37], v[60:61]
v_mov_b64 v[38:39], v[62:63]
v_mov_b64 v[40:41], v[60:61]
v_mov_b64 v[42:43], v[62:63]
v_mov_b64 v[44:45], v[60:61]
v_mov_b64 v[46:47], v[62:63]
v_mov_b64 v[48:49], v[60:61]
v_mov_b64 v[50:51], v[62:63]
v_mov_b64 v[52:53], v[60:61]
v_mov_b64 v[54:55], v[62:63]
v_mov_b64 v[56:57], v[60:61]
v_mov_b64 v[58:59], v[62:63]
v_mov_b64 v[64:65], v[92:93]
v_mov_b64 v[66:67], v[94:95]
v_mov_b64 v[68:69], v[92:93]
v_mov_b64 v[70:71], v[94:95]
s_mov_b32 m0, s45
s_nop 0
buffer_load_dwordx4 v1, s[8:11], s42 offen offset:0 lds
v_mov_b64 v[72:73], v[92:93]
v_mov_b64 v[74:75], v[94:95]
v_mov_b64 v[76:77], v[92:93]
v_mov_b64 v[78:79], v[94:95]
v_mov_b64 v[80:81], v[92:93]
v_mov_b64 v[82:83], v[94:95]
v_mov_b64 v[84:85], v[92:93]
v_mov_b64 v[86:87], v[94:95]
v_mov_b64 v[88:89], v[92:93]
v_mov_b64 v[90:91], v[94:95]
v_mov_b64 v[96:97], v[124:125]
v_mov_b64 v[98:99], v[126:127]
v_mov_b64 v[100:101], v[124:125]
v_mov_b64 v[102:103], v[126:127]
v_mov_b64 v[104:105], v[124:125]
v_mov_b64 v[106:107], v[126:127]
v_mov_b64 v[108:109], v[124:125]
buffer_load_dwordx4 v2, s[8:11], s42 offen offset:1024 lds
v_mov_b64 v[110:111], v[126:127]
v_mov_b64 v[112:113], v[124:125]
v_mov_b64 v[114:115], v[126:127]
v_mov_b64 v[116:117], v[124:125]
v_mov_b64 v[118:119], v[126:127]
v_mov_b64 v[120:121], v[124:125]
v_mov_b64 v[122:123], v[126:127]
v_mov_b64 v[128:129], v[156:157]
v_mov_b64 v[130:131], v[158:159]
v_mov_b64 v[132:133], v[156:157]
v_mov_b64 v[134:135], v[158:159]
v_mov_b64 v[136:137], v[156:157]
v_mov_b64 v[138:139], v[158:159]
v_mov_b64 v[140:141], v[156:157]
v_mov_b64 v[142:143], v[158:159]
v_mov_b64 v[144:145], v[156:157]
v_mov_b64 v[146:147], v[158:159]
buffer_load_dwordx4 v3, s[8:11], s42 offen offset:2048 lds
v_mov_b64 v[148:149], v[156:157]
v_mov_b64 v[150:151], v[158:159]
v_mov_b64 v[152:153], v[156:157]
v_mov_b64 v[154:155], v[158:159]
v_mov_b64 v[160:161], v[188:189]
v_mov_b64 v[162:163], v[190:191]
v_mov_b64 v[164:165], v[188:189]
v_mov_b64 v[166:167], v[190:191]
v_mov_b64 v[168:169], v[188:189]
v_mov_b64 v[170:171], v[190:191]
v_mov_b64 v[172:173], v[188:189]
v_mov_b64 v[174:175], v[190:191]
v_mov_b64 v[176:177], v[188:189]
v_mov_b64 v[178:179], v[190:191]
v_mov_b64 v[180:181], v[188:189]
v_mov_b64 v[182:183], v[190:191]
v_mov_b64 v[184:185], v[188:189]
buffer_load_dwordx4 v4, s[8:11], s42 offen offset:3072 lds
v_mov_b64 v[186:187], v[190:191]
v_mov_b64 v[192:193], v[220:221]
v_mov_b64 v[194:195], v[222:223]
v_mov_b64 v[196:197], v[220:221]
v_mov_b64 v[198:199], v[222:223]
v_mov_b64 v[200:201], v[220:221]
v_mov_b64 v[202:203], v[222:223]
v_mov_b64 v[204:205], v[220:221]
v_mov_b64 v[206:207], v[222:223]
v_mov_b64 v[208:209], v[220:221]
v_mov_b64 v[210:211], v[222:223]
v_mov_b64 v[212:213], v[220:221]
v_mov_b64 v[214:215], v[222:223]
v_mov_b64 v[216:217], v[220:221]
v_mov_b64 v[218:219], v[222:223]
v_mov_b64 v[224:225], v[252:253]
v_mov_b64 v[226:227], v[254:255]
s_mov_b32 m0, s46
s_nop 0
buffer_load_dwordx4 v8, s[12:15], s43 offen lds
v_mov_b64 v[228:229], v[252:253]
v_mov_b64 v[230:231], v[254:255]
v_mov_b64 v[232:233], v[252:253]
v_mov_b64 v[234:235], v[254:255]
v_mov_b64 v[236:237], v[252:253]
v_mov_b64 v[238:239], v[254:255]
v_mov_b64 v[240:241], v[252:253]
v_mov_b64 v[242:243], v[254:255]
v_mov_b64 v[244:245], v[252:253]
v_mov_b64 v[246:247], v[254:255]
v_mov_b64 v[248:249], v[252:253]
v_mov_b64 v[250:251], v[254:255]
s_waitcnt vmcnt(15)
s_mov_b32 s4, s100
s_mov_b32 s5, s101
s_mov_b32 s6, 256
s_mov_b32 s7, 0x00020000
s_lshr_b32 s24, s2, 3
s_and_b32 s24, s24, 7
s_cmp_eq_u32 s28, 0
s_cselect_b32 s24, s24, -1
s_lshr_b32 s25, s2, 3
s_and_b32 s25, s25, 3
s_add_u32 s25, s25, 3
v_mov_b32 v17, 1
v_mov_b32 v18, 0
s_barrier
ds_read_b64_tr_b16 a[80:81], v11 offset:0
ds_read_b128 a[0:3], v9 offset:0
ds_read_b64_tr_b16 a[82:83], v11 offset:512
ds_read_b64_tr_b16 a[84:85], v12 offset:0
ds_read_b128 a[4:7], v9 offset:2048
ds_read_b64_tr_b16 a[86:87], v12 offset:512
ds_read_b128 a[8:11], v9 offset:4096
ds_read_b64_tr_b16 a[88:89], v11 offset:1024
ds_read_b64_tr_b16 a[90:91], v11 offset:1536
ds_read_b128 a[12:15], v9 offset:6144
ds_read_b64_tr_b16 a[92:93], v12 offset:1024
ds_read_b64_tr_b16 a[94:95], v12 offset:1536
ds_read_b128 a[16:19], v9 offset:8192
ds_read_b64_tr_b16 a[96:97], v11 offset:2048
ds_read_b64_tr_b16 a[98:99], v11 offset:2560
ds_read_b128 a[20:23], v9 offset:10240
ds_read_b64_tr_b16 a[100:101], v12 offset:2048
ds_read_b128 a[24:27], v9 offset:12288
ds_read_b64_tr_b16 a[102:103], v12 offset:2560
ds_read_b64_tr_b16 a[104:105], v13 offset:0
ds_read_b128 a[28:31], v9 offset:14336
ds_read_b64_tr_b16 a[106:107], v13 offset:256
s_add_u32 s38, s38, 32
s_and_b32 s38, s38, 1023
s_mul_i32 s39, s38, 7168
s_mov_b32 m0, s37
s_nop 0
buffer_load_dwordx4 v5, s[12:15], s39 offen offset:0 lds
buffer_load_dwordx4 v6, s[12:15], s39 offen offset:1024 lds
buffer_load_dwordx4 v7, s[12:15], s39 offen offset:2048 lds
s_add_u32 s40, s40, 128
s_and_b32 s40, s40, 2047
s_add_u32 s41, s40, s52
s_add_u32 s42, s41, 65536
s_mul_i32 s43, s40, 3584
s_mov_b32 s47, 65536
s_add_u32 s44, s47, s53
s_add_u32 s45, s44, 4096
s_lshr_b32 s50, s47, 3
s_add_u32 s46, s50, s54
s_mov_b32 m0, s44
s_nop 0
buffer_load_dwordx4 v1, s[8:11], s41 offen offset:0 lds
buffer_load_dwordx4 v2, s[8:11], s41 offen offset:1024 lds
buffer_load_dwordx4 v3, s[8:11], s41 offen offset:2048 lds
buffer_load_dwordx4 v4, s[8:11], s41 offen offset:3072 lds
s_mov_b32 s47, 0
s_lshl_b32 s50, s2, 7
s_add_u32 s50, s50, 23625728
v_mov_b32 v14, 0
v_lshlrev_b32 v15, 2, v0
v_and_b32 v15, 127, v15
buffer_store_dword v14, v15, s[16:19], s50 offen sc1
s_waitcnt vmcnt(20) lgkmcnt(0)
s_barrier
s_mov_b32 s33, 0
L_loop_w1:
s_cmp_eq_u32 s33, 7
s_cselect_b32 s10, 0, s10
s_cselect_b32 s14, 0, s14
v_mfma_f32_16x16x32_bf16 v[32:35], a[80:83], a[0:3], v[32:35]
v_mfma_f32_16x16x32_bf16 v[36:39], a[80:83], a[4:7], v[36:39]
ds_read_b64_tr_b16 a[108:109], v11 offset:12288
v_mfma_f32_16x16x32_bf16 v[40:43], a[80:83], a[8:11], v[40:43]
v_mfma_f32_16x16x32_bf16 v[44:47], a[80:83], a[12:15], v[44:47]
ds_read_b128 a[40:43], v10 offset:0
v_mfma_f32_16x16x32_bf16 v[48:51], a[80:83], a[16:19], v[48:51]
v_mfma_f32_16x16x32_bf16 v[52:55], a[80:83], a[20:23], v[52:55]
ds_read_b64_tr_b16 a[110:111], v11 offset:12800
v_mfma_f32_16x16x32_bf16 v[56:59], a[80:83], a[24:27], v[56:59]
v_mfma_f32_16x16x32_bf16 v[60:63], a[80:83], a[28:31], v[60:63]
ds_read_b64_tr_b16 a[112:113], v12 offset:12288
v_mfma_f32_16x16x32_bf16 v[64:67], a[84:87], a[0:3], v[64:67]
v_mfma_f32_16x16x32_bf16 v[68:71], a[84:87], a[4:7], v[68:71]
ds_read_b128 a[44:47], v10 offset:2048
s_add_u32 s38, s38, 32
s_and_b32 s38, s38, 1023
s_mul_i32 s39, s38, 7168
s_mov_b32 m0, s34
v_mfma_f32_16x16x32_bf16 v[72:75], a[84:87], a[8:11], v[72:75]
v_mfma_f32_16x16x32_bf16 v[76:79], a[84:87], a[12:15], v[76:79]
ds_read_b64_tr_b16 a[114:115], v12 offset:12800
v_mfma_f32_16x16x32_bf16 v[80:83], a[84:87], a[16:19], v[80:83]
s_cmp_eq_u32 s33, s25
s_cbranch_scc0 L_nopf_w1
buffer_load_dword v28, v30, s[96:99], s71 offen
buffer_load_dword v28, v29, s[92:95], s55 offen
L_nopf_w1:
v_mfma_f32_16x16x32_bf16 v[84:87], a[84:87], a[20:23], v[84:87]
ds_read_b128 a[48:51], v10 offset:4096
v_mfma_f32_16x16x32_bf16 v[88:91], a[84:87], a[24:27], v[88:91]
buffer_load_dwordx4 v5, s[12:15], s39 offen offset:0 lds
v_mfma_f32_16x16x32_bf16 v[92:95], a[84:87], a[28:31], v[92:95]
ds_read_b64_tr_b16 a[116:117], v11 offset:13312
v_mfma_f32_16x16x32_bf16 v[96:99], a[88:91], a[0:3], v[96:99]
v_mfma_f32_16x16x32_bf16 v[100:103], a[88:91], a[4:7], v[100:103]
ds_read_b64_tr_b16 a[118:119], v11 offset:13824
v_mfma_f32_16x16x32_bf16 v[104:107], a[88:91], a[8:11], v[104:107]
buffer_load_dwordx4 v6, s[12:15], s39 offen offset:1024 lds
v_mfma_f32_16x16x32_bf16 v[108:111], a[88:91], a[12:15], v[108:111]
ds_read_b128 a[52:55], v10 offset:6144
v_mfma_f32_16x16x32_bf16 v[112:115], a[88:91], a[16:19], v[112:115]
v_mfma_f32_16x16x32_bf16 v[116:119], a[88:91], a[20:23], v[116:119]
ds_read_b64_tr_b16 a[120:121], v12 offset:13312
v_mfma_f32_16x16x32_bf16 v[120:123], a[88:91], a[24:27], v[120:123]
buffer_load_dwordx4 v7, s[12:15], s39 offen offset:2048 lds
v_mfma_f32_16x16x32_bf16 v[124:127], a[88:91], a[28:31], v[124:127]
v_mfma_f32_16x16x32_bf16 v[128:131], a[92:95], a[0:3], v[128:131]
ds_read_b64_tr_b16 a[122:123], v12 offset:13824
v_mfma_f32_16x16x32_bf16 v[132:135], a[92:95], a[4:7], v[132:135]
v_mfma_f32_16x16x32_bf16 v[136:139], a[92:95], a[8:11], v[136:139]
ds_read_b128 a[56:59], v10 offset:8192
s_mov_b32 m0, s45
v_mfma_f32_16x16x32_bf16 v[140:143], a[92:95], a[12:15], v[140:143]
v_mfma_f32_16x16x32_bf16 v[144:147], a[92:95], a[16:19], v[144:147]
ds_read_b64_tr_b16 a[124:125], v11 offset:14336
v_mfma_f32_16x16x32_bf16 v[148:151], a[92:95], a[20:23], v[148:151]
v_mfma_f32_16x16x32_bf16 v[152:155], a[92:95], a[24:27], v[152:155]
ds_read_b64_tr_b16 a[126:127], v11 offset:14848
v_mfma_f32_16x16x32_bf16 v[156:159], a[92:95], a[28:31], v[156:159]
buffer_load_dwordx4 v1, s[8:11], s42 offen offset:0 lds
v_mfma_f32_16x16x32_bf16 v[160:163], a[96:99], a[0:3], v[160:163]
ds_read_b128 a[60:63], v10 offset:10240
v_mfma_f32_16x16x32_bf16 v[164:167], a[96:99], a[4:7], v[164:167]
v_mfma_f32_16x16x32_bf16 v[168:171], a[96:99], a[8:11], v[168:171]
ds_read_b64_tr_b16 a[128:129], v12 offset:14336
v_mfma_f32_16x16x32_bf16 v[172:175], a[96:99], a[12:15], v[172:175]
buffer_load_dwordx4 v2, s[8:11], s42 offen offset:1024 lds
v_mfma_f32_16x16x32_bf16 v[176:179], a[96:99], a[16:19], v[176:179]
ds_read_b128 a[64:67], v10 offset:12288
v_mfma_f32_16x16x32_bf16 v[180:183], a[96:99], a[20:23], v[180:183]
v_mfma_f32_16x16x32_bf16 v[184:187], a[96:99], a[24:27], v[184:187]
ds_read_b64_tr_b16 a[130:131], v12 offset:14848
v_mfma_f32_16x16x32_bf16 v[188:191], a[96:99], a[28:31], v[188:191]
buffer_load_dwordx4 v3, s[8:11], s42 offen offset:2048 lds
v_mfma_f32_16x16x32_bf16 v[192:195], a[100:103], a[0:3], v[192:195]
ds_read_b64_tr_b16 a[132:133], v13 offset:2048
v_mfma_f32_16x16x32_bf16 v[196:199], a[100:103], a[4:7], v[196:199]
v_mfma_f32_16x16x32_bf16 v[200:203], a[100:103], a[8:11], v[200:203]
ds_read_b128 a[68:71], v10 offset:14336
v_mfma_f32_16x16x32_bf16 v[204:207], a[100:103], a[12:15], v[204:207]
buffer_load_dwordx4 v4, s[8:11], s42 offen offset:3072 lds
v_mfma_f32_16x16x32_bf16 v[208:211], a[100:103], a[16:19], v[208:211]
ds_read_b64_tr_b16 a[134:135], v13 offset:2304
v_mfma_f32_16x16x32_bf16 v[212:215], a[100:103], a[20:23], v[212:215]
v_mfma_f32_16x16x32_bf16 v[216:219], a[100:103], a[24:27], v[216:219]
v_mfma_f32_16x16x32_bf16 v[220:223], a[100:103], a[28:31], v[220:223]
s_mov_b32 m0, s46
v_mfma_f32_16x16x32_bf16 v[224:227], a[104:107], a[0:3], v[224:227]
v_mfma_f32_16x16x32_bf16 v[228:231], a[104:107], a[4:7], v[228:231]
v_mfma_f32_16x16x32_bf16 v[232:235], a[104:107], a[8:11], v[232:235]
v_mfma_f32_16x16x32_bf16 v[236:239], a[104:107], a[12:15], v[236:239]
v_mfma_f32_16x16x32_bf16 v[240:243], a[104:107], a[16:19], v[240:243]
buffer_load_dwordx4 v8, s[12:15], s43 offen lds
v_mfma_f32_16x16x32_bf16 v[244:247], a[104:107], a[20:23], v[244:247]
v_mfma_f32_16x16x32_bf16 v[248:251], a[104:107], a[24:27], v[248:251]
v_mfma_f32_16x16x32_bf16 v[252:255], a[104:107], a[28:31], v[252:255]
s_waitcnt vmcnt(15) lgkmcnt(0)
s_barrier
s_add_u32 s44, s47, s53
s_add_u32 s45, s44, 4096
s_lshr_b32 s50, s47, 3
s_add_u32 s46, s50, s54
v_mfma_f32_16x16x32_bf16 v[32:35], a[108:111], a[40:43], v[32:35]
s_add_u32 s50, s47, 32768
s_cmp_eq_u32 s50, 98304
s_cselect_b32 s50, 0, s50
v_mfma_f32_16x16x32_bf16 v[36:39], a[108:111], a[44:47], v[36:39]
s_sub_u32 s48, s50, s47
s_mov_b32 s47, s50
v_mfma_f32_16x16x32_bf16 v[40:43], a[108:111], a[48:51], v[40:43]
s_ashr_i32 s49, s48, 3
v_add_u32 v9, s48, v9
v_add_u32 v10, s48, v10
v_mfma_f32_16x16x32_bf16 v[44:47], a[108:111], a[52:55], v[44:47]
v_add_u32 v13, s49, v13
s_add_u32 s40, s40, 128
v_mfma_f32_16x16x32_bf16 v[48:51], a[108:111], a[56:59], v[48:51]
s_and_b32 s40, s40, 2047
v_mfma_f32_16x16x32_bf16 v[52:55], a[108:111], a[60:63], v[52:55]
s_add_u32 s41, s40, s52
ds_read_b64_tr_b16 a[80:81], v11 offset:24576
s_add_u32 s42, s41, 65536
v_mfma_f32_16x16x32_bf16 v[56:59], a[108:111], a[64:67], v[56:59]
s_mul_i32 s43, s40, 3584
v_mfma_f32_16x16x32_bf16 v[60:63], a[108:111], a[68:71], v[60:63]
ds_read_b128 a[0:3], v9 offset:0
v_mfma_f32_16x16x32_bf16 v[64:67], a[112:115], a[40:43], v[64:67]
v_mfma_f32_16x16x32_bf16 v[68:71], a[112:115], a[44:47], v[68:71]
ds_read_b64_tr_b16 a[82:83], v11 offset:25088
v_mfma_f32_16x16x32_bf16 v[72:75], a[112:115], a[48:51], v[72:75]
s_add_u32 s38, s38, 32
s_and_b32 s38, s38, 1023
s_mul_i32 s39, s38, 7168
s_mov_b32 m0, s35
v_mfma_f32_16x16x32_bf16 v[76:79], a[112:115], a[52:55], v[76:79]
ds_read_b64_tr_b16 a[84:85], v12 offset:24576
v_mfma_f32_16x16x32_bf16 v[80:83], a[112:115], a[56:59], v[80:83]
ds_read_b128 a[4:7], v9 offset:2048
v_mfma_f32_16x16x32_bf16 v[84:87], a[112:115], a[60:63], v[84:87]
v_mfma_f32_16x16x32_bf16 v[88:91], a[112:115], a[64:67], v[88:91]
ds_read_b64_tr_b16 a[86:87], v12 offset:25088
v_mfma_f32_16x16x32_bf16 v[92:95], a[112:115], a[68:71], v[92:95]
buffer_load_dwordx4 v5, s[12:15], s39 offen offset:0 lds
v_mfma_f32_16x16x32_bf16 v[96:99], a[116:119], a[40:43], v[96:99]
ds_read_b128 a[8:11], v9 offset:4096
v_mfma_f32_16x16x32_bf16 v[100:103], a[116:119], a[44:47], v[100:103]
v_mfma_f32_16x16x32_bf16 v[104:107], a[116:119], a[48:51], v[104:107]
ds_read_b64_tr_b16 a[88:89], v11 offset:25600
v_mfma_f32_16x16x32_bf16 v[108:111], a[116:119], a[52:55], v[108:111]
v_mfma_f32_16x16x32_bf16 v[112:115], a[116:119], a[56:59], v[112:115]
ds_read_b64_tr_b16 a[90:91], v11 offset:26112
buffer_load_dwordx4 v6, s[12:15], s39 offen offset:1024 lds
v_mfma_f32_16x16x32_bf16 v[116:119], a[116:119], a[60:63], v[116:119]
v_mfma_f32_16x16x32_bf16 v[120:123], a[116:119], a[64:67], v[120:123]
ds_read_b128 a[12:15], v9 offset:6144
v_mfma_f32_16x16x32_bf16 v[124:127], a[116:119], a[68:71], v[124:127]
v_mfma_f32_16x16x32_bf16 v[128:131], a[120:123], a[40:43], v[128:131]
ds_read_b64_tr_b16 a[92:93], v12 offset:25600
v_mfma_f32_16x16x32_bf16 v[132:135], a[120:123], a[44:47], v[132:135]
buffer_load_dwordx4 v7, s[12:15], s39 offen offset:2048 lds
v_mfma_f32_16x16x32_bf16 v[136:139], a[120:123], a[48:51], v[136:139]
ds_read_b64_tr_b16 a[94:95], v12 offset:26112
v_mfma_f32_16x16x32_bf16 v[140:143], a[120:123], a[52:55], v[140:143]
v_mfma_f32_16x16x32_bf16 v[144:147], a[120:123], a[56:59], v[144:147]
ds_read_b128 a[16:19], v9 offset:8192
v_mfma_f32_16x16x32_bf16 v[148:151], a[120:123], a[60:63], v[148:151]
ds_read_b64_tr_b16 a[96:97], v11 offset:26624
v_mfma_f32_16x16x32_bf16 v[152:155], a[120:123], a[64:67], v[152:155]
v_mfma_f32_16x16x32_bf16 v[156:159], a[120:123], a[68:71], v[156:159]
s_mov_b32 m0, s44
ds_read_b64_tr_b16 a[98:99], v11 offset:27136
v_mfma_f32_16x16x32_bf16 v[160:163], a[124:127], a[40:43], v[160:163]
v_mfma_f32_16x16x32_bf16 v[164:167], a[124:127], a[44:47], v[164:167]
ds_read_b128 a[20:23], v9 offset:10240
v_mfma_f32_16x16x32_bf16 v[168:171], a[124:127], a[48:51], v[168:171]
v_mfma_f32_16x16x32_bf16 v[172:175], a[124:127], a[52:55], v[172:175]
ds_read_b64_tr_b16 a[100:101], v12 offset:26624
v_mfma_f32_16x16x32_bf16 v[176:179], a[124:127], a[56:59], v[176:179]
buffer_load_dwordx4 v1, s[8:11], s41 offen offset:0 lds
v_mfma_f32_16x16x32_bf16 v[180:183], a[124:127], a[60:63], v[180:183]
ds_read_b128 a[24:27], v9 offset:12288
v_mfma_f32_16x16x32_bf16 v[184:187], a[124:127], a[64:67], v[184:187]
v_mfma_f32_16x16x32_bf16 v[188:191], a[124:127], a[68:71], v[188:191]
ds_read_b64_tr_b16 a[102:103], v12 offset:27136
v_mfma_f32_16x16x32_bf16 v[192:195], a[128:131], a[40:43], v[192:195]
v_mfma_f32_16x16x32_bf16 v[196:199], a[128:131], a[44:47], v[196:199]
ds_read_b64_tr_b16 a[104:105], v13 offset:0
buffer_load_dwordx4 v2, s[8:11], s41 offen offset:1024 lds
v_mfma_f32_16x16x32_bf16 v[200:203], a[128:131], a[48:51], v[200:203]
v_mfma_f32_16x16x32_bf16 v[204:207], a[128:131], a[52:55], v[204:207]
ds_read_b128 a[28:31], v9 offset:14336
v_mfma_f32_16x16x32_bf16 v[208:211], a[128:131], a[56:59], v[208:211]
ds_read_b64_tr_b16 a[106:107], v13 offset:256
v_mfma_f32_16x16x32_bf16 v[212:215], a[128:131], a[60:63], v[212:215]
v_mfma_f32_16x16x32_bf16 v[216:219], a[128:131], a[64:67], v[216:219]
buffer_load_dwordx4 v3, s[8:11], s41 offen offset:2048 lds
v_mfma_f32_16x16x32_bf16 v[220:223], a[128:131], a[68:71], v[220:223]
v_mfma_f32_16x16x32_bf16 v[224:227], a[132:135], a[40:43], v[224:227]
v_mfma_f32_16x16x32_bf16 v[228:231], a[132:135], a[44:47], v[228:231]
v_mfma_f32_16x16x32_bf16 v[232:235], a[132:135], a[48:51], v[232:235]
v_mfma_f32_16x16x32_bf16 v[236:239], a[132:135], a[52:55], v[236:239]
buffer_load_dwordx4 v4, s[8:11], s41 offen offset:3072 lds
v_mfma_f32_16x16x32_bf16 v[240:243], a[132:135], a[56:59], v[240:243]
v_mfma_f32_16x16x32_bf16 v[244:247], a[132:135], a[60:63], v[244:247]
v_mfma_f32_16x16x32_bf16 v[248:251], a[132:135], a[64:67], v[248:251]
v_mfma_f32_16x16x32_bf16 v[252:255], a[132:135], a[68:71], v[252:255]
s_waitcnt vmcnt(15) lgkmcnt(0)
s_barrier
v_mfma_f32_16x16x32_bf16 v[32:35], a[80:83], a[0:3], v[32:35]
v_mfma_f32_16x16x32_bf16 v[36:39], a[80:83], a[4:7], v[36:39]
ds_read_b64_tr_b16 a[108:109], v11 offset:36864
v_mfma_f32_16x16x32_bf16 v[40:43], a[80:83], a[8:11], v[40:43]
v_mfma_f32_16x16x32_bf16 v[44:47], a[80:83], a[12:15], v[44:47]
ds_read_b128 a[40:43], v10 offset:0
v_mfma_f32_16x16x32_bf16 v[48:51], a[80:83], a[16:19], v[48:51]
v_mfma_f32_16x16x32_bf16 v[52:55], a[80:83], a[20:23], v[52:55]
ds_read_b64_tr_b16 a[110:111], v11 offset:37376
v_mfma_f32_16x16x32_bf16 v[56:59], a[80:83], a[24:27], v[56:59]
v_mfma_f32_16x16x32_bf16 v[60:63], a[80:83], a[28:31], v[60:63]
ds_read_b64_tr_b16 a[112:113], v12 offset:36864
v_mfma_f32_16x16x32_bf16 v[64:67], a[84:87], a[0:3], v[64:67]
v_mfma_f32_16x16x32_bf16 v[68:71], a[84:87], a[4:7], v[68:71]
ds_read_b128 a[44:47], v10 offset:2048
s_add_u32 s38, s38, 32
s_and_b32 s38, s38, 1023
s_mul_i32 s39, s38, 7168
s_mov_b32 m0, s36
v_mfma_f32_16x16x32_bf16 v[72:75], a[84:87], a[8:11], v[72:75]
v_mfma_f32_16x16x32_bf16 v[76:79], a[84:87], a[12:15], v[76:79]
ds_read_b64_tr_b16 a[114:115], v12 offset:37376
v_mfma_f32_16x16x32_bf16 v[80:83], a[84:87], a[16:19], v[80:83]
v_mfma_f32_16x16x32_bf16 v[84:87], a[84:87], a[20:23], v[84:87]
ds_read_b128 a[48:51], v10 offset:4096
v_mfma_f32_16x16x32_bf16 v[88:91], a[84:87], a[24:27], v[88:91]
buffer_load_dwordx4 v5, s[12:15], s39 offen offset:0 lds
v_mfma_f32_16x16x32_bf16 v[92:95], a[84:87], a[28:31], v[92:95]
ds_read_b64_tr_b16 a[116:117], v11 offset:37888
v_mfma_f32_16x16x32_bf16 v[96:99], a[88:91], a[0:3], v[96:99]
v_mfma_f32_16x16x32_bf16 v[100:103], a[88:91], a[4:7], v[100:103]
s_cmp_eq_u32 s33, s24
s_cbranch_scc0 L_noinit_w1
s_mov_b64 exec, 1
buffer_atomic_add v17, v18, s[4:7], 0 offen sc1
s_mov_b64 exec, -1
L_noinit_w1:
ds_read_b64_tr_b16 a[118:119], v11 offset:38400
v_mfma_f32_16x16x32_bf16 v[104:107], a[88:91], a[8:11], v[104:107]
buffer_load_dwordx4 v6, s[12:15], s39 offen offset:1024 lds
v_mfma_f32_16x16x32_bf16 v[108:111], a[88:91], a[12:15], v[108:111]
ds_read_b128 a[52:55], v10 offset:6144
v_mfma_f32_16x16x32_bf16 v[112:115], a[88:91], a[16:19], v[112:115]
v_mfma_f32_16x16x32_bf16 v[116:119], a[88:91], a[20:23], v[116:119]
ds_read_b64_tr_b16 a[120:121], v12 offset:37888
v_mfma_f32_16x16x32_bf16 v[120:123], a[88:91], a[24:27], v[120:123]
buffer_load_dwordx4 v7, s[12:15], s39 offen offset:2048 lds
v_mfma_f32_16x16x32_bf16 v[124:127], a[88:91], a[28:31], v[124:127]
v_mfma_f32_16x16x32_bf16 v[128:131], a[92:95], a[0:3], v[128:131]
ds_read_b64_tr_b16 a[122:123], v12 offset:38400
v_mfma_f32_16x16x32_bf16 v[132:135], a[92:95], a[4:7], v[132:135]
v_mfma_f32_16x16x32_bf16 v[136:139], a[92:95], a[8:11], v[136:139]
ds_read_b128 a[56:59], v10 offset:8192
s_mov_b32 m0, s45
v_mfma_f32_16x16x32_bf16 v[140:143], a[92:95], a[12:15], v[140:143]
v_mfma_f32_16x16x32_bf16 v[144:147], a[92:95], a[16:19], v[144:147]
ds_read_b64_tr_b16 a[124:125], v11 offset:38912
v_mfma_f32_16x16x32_bf16 v[148:151], a[92:95], a[20:23], v[148:151]
v_mfma_f32_16x16x32_bf16 v[152:155], a[92:95], a[24:27], v[152:155]
ds_read_b64_tr_b16 a[126:127], v11 offset:39424
v_mfma_f32_16x16x32_bf16 v[156:159], a[92:95], a[28:31], v[156:159]
buffer_load_dwordx4 v1, s[8:11], s42 offen offset:0 lds
v_mfma_f32_16x16x32_bf16 v[160:163], a[96:99], a[0:3], v[160:163]
ds_read_b128 a[60:63], v10 offset:10240
v_mfma_f32_16x16x32_bf16 v[164:167], a[96:99], a[4:7], v[164:167]
v_mfma_f32_16x16x32_bf16 v[168:171], a[96:99], a[8:11], v[168:171]
ds_read_b64_tr_b16 a[128:129], v12 offset:38912
v_mfma_f32_16x16x32_bf16 v[172:175], a[96:99], a[12:15], v[172:175]
buffer_load_dwordx4 v2, s[8:11], s42 offen offset:1024 lds
v_mfma_f32_16x16x32_bf16 v[176:179], a[96:99], a[16:19], v[176:179]
ds_read_b128 a[64:67], v10 offset:12288
v_mfma_f32_16x16x32_bf16 v[180:183], a[96:99], a[20:23], v[180:183]
v_mfma_f32_16x16x32_bf16 v[184:187], a[96:99], a[24:27], v[184:187]
ds_read_b64_tr_b16 a[130:131], v12 offset:39424
v_mfma_f32_16x16x32_bf16 v[188:191], a[96:99], a[28:31], v[188:191]
buffer_load_dwordx4 v3, s[8:11], s42 offen offset:2048 lds
v_mfma_f32_16x16x32_bf16 v[192:195], a[100:103], a[0:3], v[192:195]
ds_read_b64_tr_b16 a[132:133], v13 offset:2048
v_mfma_f32_16x16x32_bf16 v[196:199], a[100:103], a[4:7], v[196:199]
v_mfma_f32_16x16x32_bf16 v[200:203], a[100:103], a[8:11], v[200:203]
ds_read_b128 a[68:71], v10 offset:14336
v_mfma_f32_16x16x32_bf16 v[204:207], a[100:103], a[12:15], v[204:207]
buffer_load_dwordx4 v4, s[8:11], s42 offen offset:3072 lds
v_mfma_f32_16x16x32_bf16 v[208:211], a[100:103], a[16:19], v[208:211]
ds_read_b64_tr_b16 a[134:135], v13 offset:2304
v_mfma_f32_16x16x32_bf16 v[212:215], a[100:103], a[20:23], v[212:215]
v_mfma_f32_16x16x32_bf16 v[216:219], a[100:103], a[24:27], v[216:219]
v_mfma_f32_16x16x32_bf16 v[220:223], a[100:103], a[28:31], v[220:223]
s_mov_b32 m0, s46
v_mfma_f32_16x16x32_bf16 v[224:227], a[104:107], a[0:3], v[224:227]
v_mfma_f32_16x16x32_bf16 v[228:231], a[104:107], a[4:7], v[228:231]
v_mfma_f32_16x16x32_bf16 v[232:235], a[104:107], a[8:11], v[232:235]
v_mfma_f32_16x16x32_bf16 v[236:239], a[104:107], a[12:15], v[236:239]
v_mfma_f32_16x16x32_bf16 v[240:243], a[104:107], a[16:19], v[240:243]
buffer_load_dwordx4 v8, s[12:15], s43 offen lds
v_mfma_f32_16x16x32_bf16 v[244:247], a[104:107], a[20:23], v[244:247]
v_mfma_f32_16x16x32_bf16 v[248:251], a[104:107], a[24:27], v[248:251]
v_mfma_f32_16x16x32_bf16 v[252:255], a[104:107], a[28:31], v[252:255]
s_waitcnt vmcnt(15) lgkmcnt(0)
s_barrier
s_add_u32 s44, s47, s53
s_add_u32 s45, s44, 4096
s_lshr_b32 s50, s47, 3
s_add_u32 s46, s50, s54
v_mfma_f32_16x16x32_bf16 v[32:35], a[108:111], a[40:43], v[32:35]
s_add_u32 s50, s47, 32768
s_cmp_eq_u32 s50, 98304
s_cselect_b32 s50, 0, s50
v_mfma_f32_16x16x32_bf16 v[36:39], a[108:111], a[44:47], v[36:39]
s_sub_u32 s48, s50, s47
s_mov_b32 s47, s50
v_mfma_f32_16x16x32_bf16 v[40:43], a[108:111], a[48:51], v[40:43]
s_ashr_i32 s49, s48, 3
v_add_u32 v9, s48, v9
v_add_u32 v10, s48, v10
v_mfma_f32_16x16x32_bf16 v[44:47], a[108:111], a[52:55], v[44:47]
v_add_u32 v13, s49, v13
s_add_u32 s40, s40, 128
v_mfma_f32_16x16x32_bf16 v[48:51], a[108:111], a[56:59], v[48:51]
s_and_b32 s40, s40, 2047
v_mfma_f32_16x16x32_bf16 v[52:55], a[108:111], a[60:63], v[52:55]
s_add_u32 s41, s40, s52
ds_read_b64_tr_b16 a[80:81], v11 offset:0
s_add_u32 s42, s41, 65536
v_mfma_f32_16x16x32_bf16 v[56:59], a[108:111], a[64:67], v[56:59]
s_mul_i32 s43, s40, 3584
v_mfma_f32_16x16x32_bf16 v[60:63], a[108:111], a[68:71], v[60:63]
ds_read_b128 a[0:3], v9 offset:0
v_mfma_f32_16x16x32_bf16 v[64:67], a[112:115], a[40:43], v[64:67]
v_mfma_f32_16x16x32_bf16 v[68:71], a[112:115], a[44:47], v[68:71]
ds_read_b64_tr_b16 a[82:83], v11 offset:512
v_mfma_f32_16x16x32_bf16 v[72:75], a[112:115], a[48:51], v[72:75]
s_add_u32 s38, s38, 32
s_and_b32 s38, s38, 1023
s_mul_i32 s39, s38, 7168
s_mov_b32 m0, s37
v_mfma_f32_16x16x32_bf16 v[76:79], a[112:115], a[52:55], v[76:79]
ds_read_b64_tr_b16 a[84:85], v12 offset:0
v_mfma_f32_16x16x32_bf16 v[80:83], a[112:115], a[56:59], v[80:83]
ds_read_b128 a[4:7], v9 offset:2048
v_mfma_f32_16x16x32_bf16 v[84:87], a[112:115], a[60:63], v[84:87]
v_mfma_f32_16x16x32_bf16 v[88:91], a[112:115], a[64:67], v[88:91]
ds_read_b64_tr_b16 a[86:87], v12 offset:512
v_mfma_f32_16x16x32_bf16 v[92:95], a[112:115], a[68:71], v[92:95]
buffer_load_dwordx4 v5, s[12:15], s39 offen offset:0 lds
v_mfma_f32_16x16x32_bf16 v[96:99], a[116:119], a[40:43], v[96:99]
ds_read_b128 a[8:11], v9 offset:4096
v_mfma_f32_16x16x32_bf16 v[100:103], a[116:119], a[44:47], v[100:103]
v_mfma_f32_16x16x32_bf16 v[104:107], a[116:119], a[48:51], v[104:107]
ds_read_b64_tr_b16 a[88:89], v11 offset:1024
v_mfma_f32_16x16x32_bf16 v[108:111], a[116:119], a[52:55], v[108:111]
v_mfma_f32_16x16x32_bf16 v[112:115], a[116:119], a[56:59], v[112:115]
ds_read_b64_tr_b16 a[90:91], v11 offset:1536
buffer_load_dwordx4 v6, s[12:15], s39 offen offset:1024 lds
v_mfma_f32_16x16x32_bf16 v[116:119], a[116:119], a[60:63], v[116:119]
v_mfma_f32_16x16x32_bf16 v[120:123], a[116:119], a[64:67], v[120:123]
ds_read_b128 a[12:15], v9 offset:6144
v_mfma_f32_16x16x32_bf16 v[124:127], a[116:119], a[68:71], v[124:127]
v_mfma_f32_16x16x32_bf16 v[128:131], a[120:123], a[40:43], v[128:131]
ds_read_b64_tr_b16 a[92:93], v12 offset:1024
v_mfma_f32_16x16x32_bf16 v[132:135], a[120:123], a[44:47], v[132:135]
buffer_load_dwordx4 v7, s[12:15], s39 offen offset:2048 lds
v_mfma_f32_16x16x32_bf16 v[136:139], a[120:123], a[48:51], v[136:139]
ds_read_b64_tr_b16 a[94:95], v12 offset:1536
v_mfma_f32_16x16x32_bf16 v[140:143], a[120:123], a[52:55], v[140:143]
v_mfma_f32_16x16x32_bf16 v[144:147], a[120:123], a[56:59], v[144:147]
ds_read_b128 a[16:19], v9 offset:8192
v_mfma_f32_16x16x32_bf16 v[148:151], a[120:123], a[60:63], v[148:151]
ds_read_b64_tr_b16 a[96:97], v11 offset:2048
v_mfma_f32_16x16x32_bf16 v[152:155], a[120:123], a[64:67], v[152:155]
v_mfma_f32_16x16x32_bf16 v[156:159], a[120:123], a[68:71], v[156:159]
s_mov_b32 m0, s44
ds_read_b64_tr_b16 a[98:99], v11 offset:2560
v_mfma_f32_16x16x32_bf16 v[160:163], a[124:127], a[40:43], v[160:163]
v_mfma_f32_16x16x32_bf16 v[164:167], a[124:127], a[44:47], v[164:167]
ds_read_b128 a[20:23], v9 offset:10240
v_mfma_f32_16x16x32_bf16 v[168:171], a[124:127], a[48:51], v[168:171]
v_mfma_f32_16x16x32_bf16 v[172:175], a[124:127], a[52:55], v[172:175]
ds_read_b64_tr_b16 a[100:101], v12 offset:2048
v_mfma_f32_16x16x32_bf16 v[176:179], a[124:127], a[56:59], v[176:179]
buffer_load_dwordx4 v1, s[8:11], s41 offen offset:0 lds
v_mfma_f32_16x16x32_bf16 v[180:183], a[124:127], a[60:63], v[180:183]
ds_read_b128 a[24:27], v9 offset:12288
v_mfma_f32_16x16x32_bf16 v[184:187], a[124:127], a[64:67], v[184:187]
v_mfma_f32_16x16x32_bf16 v[188:191], a[124:127], a[68:71], v[188:191]
ds_read_b64_tr_b16 a[102:103], v12 offset:2560
v_mfma_f32_16x16x32_bf16 v[192:195], a[128:131], a[40:43], v[192:195]
v_mfma_f32_16x16x32_bf16 v[196:199], a[128:131], a[44:47], v[196:199]
ds_read_b64_tr_b16 a[104:105], v13 offset:0
buffer_load_dwordx4 v2, s[8:11], s41 offen offset:1024 lds
v_mfma_f32_16x16x32_bf16 v[200:203], a[128:131], a[48:51], v[200:203]
v_mfma_f32_16x16x32_bf16 v[204:207], a[128:131], a[52:55], v[204:207]
ds_read_b128 a[28:31], v9 offset:14336
v_mfma_f32_16x16x32_bf16 v[208:211], a[128:131], a[56:59], v[208:211]
ds_read_b64_tr_b16 a[106:107], v13 offset:256
v_mfma_f32_16x16x32_bf16 v[212:215], a[128:131], a[60:63], v[212:215]
v_mfma_f32_16x16x32_bf16 v[216:219], a[128:131], a[64:67], v[216:219]
buffer_load_dwordx4 v3, s[8:11], s41 offen offset:2048 lds
v_mfma_f32_16x16x32_bf16 v[220:223], a[128:131], a[68:71], v[220:223]
v_mfma_f32_16x16x32_bf16 v[224:227], a[132:135], a[40:43], v[224:227]
v_mfma_f32_16x16x32_bf16 v[228:231], a[132:135], a[44:47], v[228:231]
v_mfma_f32_16x16x32_bf16 v[232:235], a[132:135], a[48:51], v[232:235]
v_mfma_f32_16x16x32_bf16 v[236:239], a[132:135], a[52:55], v[236:239]
buffer_load_dwordx4 v4, s[8:11], s41 offen offset:3072 lds
v_mfma_f32_16x16x32_bf16 v[240:243], a[132:135], a[56:59], v[240:243]
v_mfma_f32_16x16x32_bf16 v[244:247], a[132:135], a[60:63], v[244:247]
v_mfma_f32_16x16x32_bf16 v[248:251], a[132:135], a[64:67], v[248:251]
v_mfma_f32_16x16x32_bf16 v[252:255], a[132:135], a[68:71], v[252:255]
s_waitcnt vmcnt(15) lgkmcnt(0)
s_barrier
s_add_u32 s33, s33, 1
s_cmp_lt_u32 s33, 8
s_cbranch_scc1 L_loop_w1
s_waitcnt vmcnt(0)
s_barrier
s_lshl_b32 s50, s31, 1
s_add_u32 s50, s50, s29
s_mul_i32 s50, s50, 1474560
s_lshr_b32 s51, s68, 4
s_lshl_b32 s70, s30, 1
s_add_u32 s51, s51, s70
s_add_u32 s51, s51, 64
s_mul_i32 s51, s51, 5120
s_add_u32 s65, s50, s51
s_lshr_b32 s51, s69, 4
s_add_u32 s51, s51, s30
s_add_u32 s51, s51, 64
s_mul_i32 s51, s51, 5120
s_add_u32 s66, s50, s51
v_lshrrev_b32 v30, 3, v0
v_lshlrev_b32 v30, 2, v30
s_mov_b32 s70, 286330880
v_bfe_u32 v26, s70, v30, 4
s_mov_b32 s70, 572662289
v_max_f32 v32, 0, v32
v_max_f32 v33, 0, v33
v_max_f32 v34, 0, v34
v_max_f32 v35, 0, v35
v_max_f32 v36, 0, v36
v_max_f32 v37, 0, v37
v_max_f32 v38, 0, v38
v_max_f32 v39, 0, v39
v_bfe_u32 v27, s70, v30, 4
v_pk_mul_f32 v[32:33], v[32:33], v[32:33]
v_pk_mul_f32 v[34:35], v[34:35], v[34:35]
v_pk_mul_f32 v[36:37], v[36:37], v[36:37]
v_pk_mul_f32 v[38:39], v[38:39], v[38:39]
v_max_f32 v40, 0, v40
v_max_f32 v41, 0, v41
v_max_f32 v42, 0, v42
v_max_f32 v43, 0, v43
v_max_f32 v44, 0, v44
v_max_f32 v45, 0, v45
v_max_f32 v46, 0, v46
v_max_f32 v47, 0, v47
s_mov_b32 s70, 858993458
v_cvt_pk_bf16_f32 v2, v32, v33
v_cvt_pk_bf16_f32 v3, v34, v35
v_cvt_pk_bf16_f32 v4, v36, v37
v_cvt_pk_bf16_f32 v5, v38, v39
v_pk_mul_f32 v[40:41], v[40:41], v[40:41]
v_pk_mul_f32 v[42:43], v[42:43], v[42:43]
v_pk_mul_f32 v[44:45], v[44:45], v[44:45]
v_pk_mul_f32 v[46:47], v[46:47], v[46:47]
v_bfe_u32 v28, s70, v30, 4
v_cvt_pk_bf16_f32 v6, v40, v41
v_cvt_pk_bf16_f32 v7, v42, v43
v_cvt_pk_bf16_f32 v8, v44, v45
v_cvt_pk_bf16_f32 v9, v46, v47
v_lshlrev_b32 v1, 4, v0
s_mov_b32 s70, 1413760068
v_lshl_add_u32 v26, v26, 7, v1
s_add_u32 s64, s65, 0
v_permlane16_swap_b32 v2, v4
v_permlane16_swap_b32 v3, v5
v_lshl_add_u32 v27, v27, 7, v1
v_bfe_u32 v29, s70, v30, 4
buffer_store_dwordx4 v[2:5], v26, s[16:19], s64 offen offset:0 sc1
v_permlane16_swap_b32 v6, v8
v_permlane16_swap_b32 v7, v9
v_lshl_add_u32 v28, v28, 7, v1
v_lshl_add_u32 v29, v29, 7, v1
buffer_store_dwordx4 v[6:9], v27, s[16:19], s64 offen offset:1024 sc1
v_max_f32 v48, 0, v48
v_max_f32 v49, 0, v49
v_max_f32 v50, 0, v50
v_max_f32 v51, 0, v51
v_max_f32 v52, 0, v52
v_max_f32 v53, 0, v53
v_max_f32 v54, 0, v54
v_max_f32 v55, 0, v55
v_pk_mul_f32 v[48:49], v[48:49], v[48:49]
v_pk_mul_f32 v[50:51], v[50:51], v[50:51]
v_pk_mul_f32 v[52:53], v[52:53], v[52:53]
v_pk_mul_f32 v[54:55], v[54:55], v[54:55]
v_max_f32 v56, 0, v56
v_max_f32 v57, 0, v57
v_max_f32 v58, 0, v58
v_max_f32 v59, 0, v59
v_max_f32 v60, 0, v60
v_max_f32 v61, 0, v61
v_max_f32 v62, 0, v62
v_max_f32 v63, 0, v63
v_cvt_pk_bf16_f32 v10, v48, v49
v_cvt_pk_bf16_f32 v11, v50, v51
v_cvt_pk_bf16_f32 v12, v52, v53
v_cvt_pk_bf16_f32 v13, v54, v55
v_pk_mul_f32 v[56:57], v[56:57], v[56:57]
v_pk_mul_f32 v[58:59], v[58:59], v[58:59]
v_pk_mul_f32 v[60:61], v[60:61], v[60:61]
v_pk_mul_f32 v[62:63], v[62:63], v[62:63]
v_cvt_pk_bf16_f32 v14, v56, v57
v_cvt_pk_bf16_f32 v15, v58, v59
v_cvt_pk_bf16_f32 v16, v60, v61
v_cvt_pk_bf16_f32 v17, v62, v63
v_permlane16_swap_b32 v10, v12
v_permlane16_swap_b32 v11, v13
buffer_store_dwordx4 v[10:13], v28, s[16:19], s64 offen offset:2048 sc1
v_permlane16_swap_b32 v14, v16
v_permlane16_swap_b32 v15, v17
buffer_store_dwordx4 v[14:17], v29, s[16:19], s64 offen offset:3072 sc1
v_max_f32 v64, 0, v64
v_max_f32 v65, 0, v65
v_max_f32 v66, 0, v66
v_max_f32 v67, 0, v67
v_max_f32 v68, 0, v68
v_max_f32 v69, 0, v69
v_max_f32 v70, 0, v70
v_max_f32 v71, 0, v71
v_pk_mul_f32 v[64:65], v[64:65], v[64:65]
v_pk_mul_f32 v[66:67], v[66:67], v[66:67]
v_pk_mul_f32 v[68:69], v[68:69], v[68:69]
v_pk_mul_f32 v[70:71], v[70:71], v[70:71]
v_max_f32 v72, 0, v72
v_max_f32 v73, 0, v73
v_max_f32 v74, 0, v74
v_max_f32 v75, 0, v75
v_max_f32 v76, 0, v76
v_max_f32 v77, 0, v77
v_max_f32 v78, 0, v78
v_max_f32 v79, 0, v79
v_cvt_pk_bf16_f32 v18, v64, v65
v_cvt_pk_bf16_f32 v19, v66, v67
v_cvt_pk_bf16_f32 v20, v68, v69
v_cvt_pk_bf16_f32 v21, v70, v71
v_pk_mul_f32 v[72:73], v[72:73], v[72:73]
v_pk_mul_f32 v[74:75], v[74:75], v[74:75]
v_pk_mul_f32 v[76:77], v[76:77], v[76:77]
v_pk_mul_f32 v[78:79], v[78:79], v[78:79]
v_cvt_pk_bf16_f32 v22, v72, v73
v_cvt_pk_bf16_f32 v23, v74, v75
v_cvt_pk_bf16_f32 v24, v76, v77
v_cvt_pk_bf16_f32 v25, v78, v79
s_add_u32 s67, s65, 5120
v_permlane16_swap_b32 v18, v20
v_permlane16_swap_b32 v19, v21
buffer_store_dwordx4 v[18:21], v26, s[16:19], s67 offen offset:0 sc1
v_permlane16_swap_b32 v22, v24
v_permlane16_swap_b32 v23, v25
buffer_store_dwordx4 v[22:25], v27, s[16:19], s67 offen offset:1024 sc1
v_max_f32 v80, 0, v80
v_max_f32 v81, 0, v81
v_max_f32 v82, 0, v82
v_max_f32 v83, 0, v83
v_max_f32 v84, 0, v84
v_max_f32 v85, 0, v85
v_max_f32 v86, 0, v86
v_max_f32 v87, 0, v87
v_pk_mul_f32 v[80:81], v[80:81], v[80:81]
v_pk_mul_f32 v[82:83], v[82:83], v[82:83]
v_pk_mul_f32 v[84:85], v[84:85], v[84:85]
v_pk_mul_f32 v[86:87], v[86:87], v[86:87]
v_max_f32 v88, 0, v88
v_max_f32 v89, 0, v89
v_max_f32 v90, 0, v90
v_max_f32 v91, 0, v91
v_max_f32 v92, 0, v92
v_max_f32 v93, 0, v93
v_max_f32 v94, 0, v94
v_max_f32 v95, 0, v95
v_cvt_pk_bf16_f32 v2, v80, v81
v_cvt_pk_bf16_f32 v3, v82, v83
v_cvt_pk_bf16_f32 v4, v84, v85
v_cvt_pk_bf16_f32 v5, v86, v87
v_pk_mul_f32 v[88:89], v[88:89], v[88:89]
v_pk_mul_f32 v[90:91], v[90:91], v[90:91]
v_pk_mul_f32 v[92:93], v[92:93], v[92:93]
v_pk_mul_f32 v[94:95], v[94:95], v[94:95]
v_cvt_pk_bf16_f32 v6, v88, v89
v_cvt_pk_bf16_f32 v7, v90, v91
v_cvt_pk_bf16_f32 v8, v92, v93
v_cvt_pk_bf16_f32 v9, v94, v95
v_permlane16_swap_b32 v2, v4
v_permlane16_swap_b32 v3, v5
buffer_store_dwordx4 v[2:5], v28, s[16:19], s67 offen offset:2048 sc1
v_permlane16_swap_b32 v6, v8
v_permlane16_swap_b32 v7, v9
buffer_store_dwordx4 v[6:9], v29, s[16:19], s67 offen offset:3072 sc1
v_max_f32 v96, 0, v96
v_max_f32 v97, 0, v97
v_max_f32 v98, 0, v98
v_max_f32 v99, 0, v99
v_max_f32 v100, 0, v100
v_max_f32 v101, 0, v101
v_max_f32 v102, 0, v102
v_max_f32 v103, 0, v103
v_pk_mul_f32 v[96:97], v[96:97], v[96:97]
v_pk_mul_f32 v[98:99], v[98:99], v[98:99]
v_pk_mul_f32 v[100:101], v[100:101], v[100:101]
v_pk_mul_f32 v[102:103], v[102:103], v[102:103]
v_max_f32 v104, 0, v104
v_max_f32 v105, 0, v105
v_max_f32 v106, 0, v106
v_max_f32 v107, 0, v107
v_max_f32 v108, 0, v108
v_max_f32 v109, 0, v109
v_max_f32 v110, 0, v110
v_max_f32 v111, 0, v111
v_cvt_pk_bf16_f32 v10, v96, v97
v_cvt_pk_bf16_f32 v11, v98, v99
v_cvt_pk_bf16_f32 v12, v100, v101
v_cvt_pk_bf16_f32 v13, v102, v103
v_pk_mul_f32 v[104:105], v[104:105], v[104:105]
v_pk_mul_f32 v[106:107], v[106:107], v[106:107]
v_pk_mul_f32 v[108:109], v[108:109], v[108:109]
v_pk_mul_f32 v[110:111], v[110:111], v[110:111]
v_cvt_pk_bf16_f32 v14, v104, v105
v_cvt_pk_bf16_f32 v15, v106, v107
v_cvt_pk_bf16_f32 v16, v108, v109
v_cvt_pk_bf16_f32 v17, v110, v111
s_add_u32 s64, s65, 20480
v_permlane16_swap_b32 v10, v12
v_permlane16_swap_b32 v11, v13
buffer_store_dwordx4 v[10:13], v26, s[16:19], s64 offen offset:0 sc1
v_permlane16_swap_b32 v14, v16
v_permlane16_swap_b32 v15, v17
buffer_store_dwordx4 v[14:17], v27, s[16:19], s64 offen offset:1024 sc1
v_max_f32 v112, 0, v112
v_max_f32 v113, 0, v113
v_max_f32 v114, 0, v114
v_max_f32 v115, 0, v115
v_max_f32 v116, 0, v116
v_max_f32 v117, 0, v117
v_max_f32 v118, 0, v118
v_max_f32 v119, 0, v119
v_pk_mul_f32 v[112:113], v[112:113], v[112:113]
v_pk_mul_f32 v[114:115], v[114:115], v[114:115]
v_pk_mul_f32 v[116:117], v[116:117], v[116:117]
v_pk_mul_f32 v[118:119], v[118:119], v[118:119]
v_max_f32 v120, 0, v120
v_max_f32 v121, 0, v121
v_max_f32 v122, 0, v122
v_max_f32 v123, 0, v123
v_max_f32 v124, 0, v124
v_max_f32 v125, 0, v125
v_max_f32 v126, 0, v126
v_max_f32 v127, 0, v127
v_cvt_pk_bf16_f32 v18, v112, v113
v_cvt_pk_bf16_f32 v19, v114, v115
v_cvt_pk_bf16_f32 v20, v116, v117
v_cvt_pk_bf16_f32 v21, v118, v119
v_pk_mul_f32 v[120:121], v[120:121], v[120:121]
v_pk_mul_f32 v[122:123], v[122:123], v[122:123]
v_pk_mul_f32 v[124:125], v[124:125], v[124:125]
v_pk_mul_f32 v[126:127], v[126:127], v[126:127]
v_cvt_pk_bf16_f32 v22, v120, v121
v_cvt_pk_bf16_f32 v23, v122, v123
v_cvt_pk_bf16_f32 v24, v124, v125
v_cvt_pk_bf16_f32 v25, v126, v127
v_permlane16_swap_b32 v18, v20
v_permlane16_swap_b32 v19, v21
buffer_store_dwordx4 v[18:21], v28, s[16:19], s64 offen offset:2048 sc1
v_permlane16_swap_b32 v22, v24
v_permlane16_swap_b32 v23, v25
buffer_store_dwordx4 v[22:25], v29, s[16:19], s64 offen offset:3072 sc1
v_max_f32 v128, 0, v128
v_max_f32 v129, 0, v129
v_max_f32 v130, 0, v130
v_max_f32 v131, 0, v131
v_max_f32 v132, 0, v132
v_max_f32 v133, 0, v133
v_max_f32 v134, 0, v134
v_max_f32 v135, 0, v135
v_pk_mul_f32 v[128:129], v[128:129], v[128:129]
v_pk_mul_f32 v[130:131], v[130:131], v[130:131]
v_pk_mul_f32 v[132:133], v[132:133], v[132:133]
v_pk_mul_f32 v[134:135], v[134:135], v[134:135]
v_max_f32 v136, 0, v136
v_max_f32 v137, 0, v137
v_max_f32 v138, 0, v138
v_max_f32 v139, 0, v139
v_max_f32 v140, 0, v140
v_max_f32 v141, 0, v141
v_max_f32 v142, 0, v142
v_max_f32 v143, 0, v143
v_cvt_pk_bf16_f32 v2, v128, v129
v_cvt_pk_bf16_f32 v3, v130, v131
v_cvt_pk_bf16_f32 v4, v132, v133
v_cvt_pk_bf16_f32 v5, v134, v135
v_pk_mul_f32 v[136:137], v[136:137], v[136:137]
v_pk_mul_f32 v[138:139], v[138:139], v[138:139]
v_pk_mul_f32 v[140:141], v[140:141], v[140:141]
v_pk_mul_f32 v[142:143], v[142:143], v[142:143]
v_cvt_pk_bf16_f32 v6, v136, v137
v_cvt_pk_bf16_f32 v7, v138, v139
v_cvt_pk_bf16_f32 v8, v140, v141
v_cvt_pk_bf16_f32 v9, v142, v143
s_add_u32 s67, s65, 25600
v_permlane16_swap_b32 v2, v4
v_permlane16_swap_b32 v3, v5
buffer_store_dwordx4 v[2:5], v26, s[16:19], s67 offen offset:0 sc1
v_permlane16_swap_b32 v6, v8
v_permlane16_swap_b32 v7, v9
buffer_store_dwordx4 v[6:9], v27, s[16:19], s67 offen offset:1024 sc1
v_max_f32 v144, 0, v144
v_max_f32 v145, 0, v145
v_max_f32 v146, 0, v146
v_max_f32 v147, 0, v147
v_max_f32 v148, 0, v148
v_max_f32 v149, 0, v149
v_max_f32 v150, 0, v150
v_max_f32 v151, 0, v151
v_pk_mul_f32 v[144:145], v[144:145], v[144:145]
v_pk_mul_f32 v[146:147], v[146:147], v[146:147]
v_pk_mul_f32 v[148:149], v[148:149], v[148:149]
v_pk_mul_f32 v[150:151], v[150:151], v[150:151]
v_max_f32 v152, 0, v152
v_max_f32 v153, 0, v153
v_max_f32 v154, 0, v154
v_max_f32 v155, 0, v155
v_max_f32 v156, 0, v156
v_max_f32 v157, 0, v157
v_max_f32 v158, 0, v158
v_max_f32 v159, 0, v159
v_cvt_pk_bf16_f32 v10, v144, v145
v_cvt_pk_bf16_f32 v11, v146, v147
v_cvt_pk_bf16_f32 v12, v148, v149
v_cvt_pk_bf16_f32 v13, v150, v151
v_pk_mul_f32 v[152:153], v[152:153], v[152:153]
v_pk_mul_f32 v[154:155], v[154:155], v[154:155]
v_pk_mul_f32 v[156:157], v[156:157], v[156:157]
v_pk_mul_f32 v[158:159], v[158:159], v[158:159]
v_cvt_pk_bf16_f32 v14, v152, v153
v_cvt_pk_bf16_f32 v15, v154, v155
v_cvt_pk_bf16_f32 v16, v156, v157
v_cvt_pk_bf16_f32 v17, v158, v159
v_permlane16_swap_b32 v10, v12
v_permlane16_swap_b32 v11, v13
buffer_store_dwordx4 v[10:13], v28, s[16:19], s67 offen offset:2048 sc1
v_permlane16_swap_b32 v14, v16
v_permlane16_swap_b32 v15, v17
buffer_store_dwordx4 v[14:17], v29, s[16:19], s67 offen offset:3072 sc1
v_max_f32 v160, 0, v160
v_max_f32 v161, 0, v161
v_max_f32 v162, 0, v162
v_max_f32 v163, 0, v163
v_max_f32 v164, 0, v164
v_max_f32 v165, 0, v165
v_max_f32 v166, 0, v166
v_max_f32 v167, 0, v167
v_pk_mul_f32 v[160:161], v[160:161], v[160:161]
v_pk_mul_f32 v[162:163], v[162:163], v[162:163]
v_pk_mul_f32 v[164:165], v[164:165], v[164:165]
v_pk_mul_f32 v[166:167], v[166:167], v[166:167]
v_max_f32 v168, 0, v168
v_max_f32 v169, 0, v169
v_max_f32 v170, 0, v170
v_max_f32 v171, 0, v171
v_max_f32 v172, 0, v172
v_max_f32 v173, 0, v173
v_max_f32 v174, 0, v174
v_max_f32 v175, 0, v175
v_cvt_pk_bf16_f32 v18, v160, v161
v_cvt_pk_bf16_f32 v19, v162, v163
v_cvt_pk_bf16_f32 v20, v164, v165
v_cvt_pk_bf16_f32 v21, v166, v167
v_pk_mul_f32 v[168:169], v[168:169], v[168:169]
v_pk_mul_f32 v[170:171], v[170:171], v[170:171]
v_pk_mul_f32 v[172:173], v[172:173], v[172:173]
v_pk_mul_f32 v[174:175], v[174:175], v[174:175]
v_cvt_pk_bf16_f32 v22, v168, v169
v_cvt_pk_bf16_f32 v23, v170, v171
v_cvt_pk_bf16_f32 v24, v172, v173
v_cvt_pk_bf16_f32 v25, v174, v175
s_add_u32 s64, s65, 40960
v_permlane16_swap_b32 v18, v20
v_permlane16_swap_b32 v19, v21
buffer_store_dwordx4 v[18:21], v26, s[16:19], s64 offen offset:0 sc1
v_permlane16_swap_b32 v22, v24
v_permlane16_swap_b32 v23, v25
buffer_store_dwordx4 v[22:25], v27, s[16:19], s64 offen offset:1024 sc1
v_max_f32 v176, 0, v176
v_max_f32 v177, 0, v177
v_max_f32 v178, 0, v178
v_max_f32 v179, 0, v179
v_max_f32 v180, 0, v180
v_max_f32 v181, 0, v181
v_max_f32 v182, 0, v182
v_max_f32 v183, 0, v183
v_pk_mul_f32 v[176:177], v[176:177], v[176:177]
v_pk_mul_f32 v[178:179], v[178:179], v[178:179]
v_pk_mul_f32 v[180:181], v[180:181], v[180:181]
v_pk_mul_f32 v[182:183], v[182:183], v[182:183]
v_max_f32 v184, 0, v184
v_max_f32 v185, 0, v185
v_max_f32 v186, 0, v186
v_max_f32 v187, 0, v187
v_max_f32 v188, 0, v188
v_max_f32 v189, 0, v189
v_max_f32 v190, 0, v190
v_max_f32 v191, 0, v191
v_cvt_pk_bf16_f32 v2, v176, v177
v_cvt_pk_bf16_f32 v3, v178, v179
v_cvt_pk_bf16_f32 v4, v180, v181
v_cvt_pk_bf16_f32 v5, v182, v183
v_pk_mul_f32 v[184:185], v[184:185], v[184:185]
v_pk_mul_f32 v[186:187], v[186:187], v[186:187]
v_pk_mul_f32 v[188:189], v[188:189], v[188:189]
v_pk_mul_f32 v[190:191], v[190:191], v[190:191]
v_cvt_pk_bf16_f32 v6, v184, v185
v_cvt_pk_bf16_f32 v7, v186, v187
v_cvt_pk_bf16_f32 v8, v188, v189
v_cvt_pk_bf16_f32 v9, v190, v191
v_permlane16_swap_b32 v2, v4
v_permlane16_swap_b32 v3, v5
buffer_store_dwordx4 v[2:5], v28, s[16:19], s64 offen offset:2048 sc1
v_permlane16_swap_b32 v6, v8
v_permlane16_swap_b32 v7, v9
buffer_store_dwordx4 v[6:9], v29, s[16:19], s64 offen offset:3072 sc1
v_max_f32 v192, 0, v192
v_max_f32 v193, 0, v193
v_max_f32 v194, 0, v194
v_max_f32 v195, 0, v195
v_max_f32 v196, 0, v196
v_max_f32 v197, 0, v197
v_max_f32 v198, 0, v198
v_max_f32 v199, 0, v199
v_pk_mul_f32 v[192:193], v[192:193], v[192:193]
v_pk_mul_f32 v[194:195], v[194:195], v[194:195]
v_pk_mul_f32 v[196:197], v[196:197], v[196:197]
v_pk_mul_f32 v[198:199], v[198:199], v[198:199]
v_max_f32 v200, 0, v200
v_max_f32 v201, 0, v201
v_max_f32 v202, 0, v202
v_max_f32 v203, 0, v203
v_max_f32 v204, 0, v204
v_max_f32 v205, 0, v205
v_max_f32 v206, 0, v206
v_max_f32 v207, 0, v207
v_cvt_pk_bf16_f32 v10, v192, v193
v_cvt_pk_bf16_f32 v11, v194, v195
v_cvt_pk_bf16_f32 v12, v196, v197
v_cvt_pk_bf16_f32 v13, v198, v199
v_pk_mul_f32 v[200:201], v[200:201], v[200:201]
v_pk_mul_f32 v[202:203], v[202:203], v[202:203]
v_pk_mul_f32 v[204:205], v[204:205], v[204:205]
v_pk_mul_f32 v[206:207], v[206:207], v[206:207]
v_cvt_pk_bf16_f32 v14, v200, v201
v_cvt_pk_bf16_f32 v15, v202, v203
v_cvt_pk_bf16_f32 v16, v204, v205
v_cvt_pk_bf16_f32 v17, v206, v207
s_add_u32 s67, s65, 46080
v_permlane16_swap_b32 v10, v12
v_permlane16_swap_b32 v11, v13
buffer_store_dwordx4 v[10:13], v26, s[16:19], s67 offen offset:0 sc1
v_permlane16_swap_b32 v14, v16
v_permlane16_swap_b32 v15, v17
buffer_store_dwordx4 v[14:17], v27, s[16:19], s67 offen offset:1024 sc1
v_max_f32 v208, 0, v208
v_max_f32 v209, 0, v209
v_max_f32 v210, 0, v210
v_max_f32 v211, 0, v211
v_max_f32 v212, 0, v212
v_max_f32 v213, 0, v213
v_max_f32 v214, 0, v214
v_max_f32 v215, 0, v215
v_pk_mul_f32 v[208:209], v[208:209], v[208:209]
v_pk_mul_f32 v[210:211], v[210:211], v[210:211]
v_pk_mul_f32 v[212:213], v[212:213], v[212:213]
v_pk_mul_f32 v[214:215], v[214:215], v[214:215]
v_max_f32 v216, 0, v216
v_max_f32 v217, 0, v217
v_max_f32 v218, 0, v218
v_max_f32 v219, 0, v219
v_max_f32 v220, 0, v220
v_max_f32 v221, 0, v221
v_max_f32 v222, 0, v222
v_max_f32 v223, 0, v223
v_cvt_pk_bf16_f32 v18, v208, v209
v_cvt_pk_bf16_f32 v19, v210, v211
v_cvt_pk_bf16_f32 v20, v212, v213
v_cvt_pk_bf16_f32 v21, v214, v215
v_pk_mul_f32 v[216:217], v[216:217], v[216:217]
v_pk_mul_f32 v[218:219], v[218:219], v[218:219]
v_pk_mul_f32 v[220:221], v[220:221], v[220:221]
v_pk_mul_f32 v[222:223], v[222:223], v[222:223]
v_cvt_pk_bf16_f32 v22, v216, v217
v_cvt_pk_bf16_f32 v23, v218, v219
v_cvt_pk_bf16_f32 v24, v220, v221
v_cvt_pk_bf16_f32 v25, v222, v223
v_permlane16_swap_b32 v18, v20
v_permlane16_swap_b32 v19, v21
buffer_store_dwordx4 v[18:21], v28, s[16:19], s67 offen offset:2048 sc1
v_permlane16_swap_b32 v22, v24
v_permlane16_swap_b32 v23, v25
buffer_store_dwordx4 v[22:25], v29, s[16:19], s67 offen offset:3072 sc1
v_max_f32 v224, 0, v224
v_max_f32 v225, 0, v225
v_max_f32 v226, 0, v226
v_max_f32 v227, 0, v227
v_max_f32 v228, 0, v228
v_max_f32 v229, 0, v229
v_max_f32 v230, 0, v230
v_max_f32 v231, 0, v231
v_pk_mul_f32 v[224:225], v[224:225], v[224:225]
v_pk_mul_f32 v[226:227], v[226:227], v[226:227]
v_pk_mul_f32 v[228:229], v[228:229], v[228:229]
v_pk_mul_f32 v[230:231], v[230:231], v[230:231]
v_max_f32 v232, 0, v232
v_max_f32 v233, 0, v233
v_max_f32 v234, 0, v234
v_max_f32 v235, 0, v235
v_max_f32 v236, 0, v236
v_max_f32 v237, 0, v237
v_max_f32 v238, 0, v238
v_max_f32 v239, 0, v239
v_cvt_pk_bf16_f32 v2, v224, v225
v_cvt_pk_bf16_f32 v3, v226, v227
v_cvt_pk_bf16_f32 v4, v228, v229
v_cvt_pk_bf16_f32 v5, v230, v231
v_pk_mul_f32 v[232:233], v[232:233], v[232:233]
v_pk_mul_f32 v[234:235], v[234:235], v[234:235]
v_pk_mul_f32 v[236:237], v[236:237], v[236:237]
v_pk_mul_f32 v[238:239], v[238:239], v[238:239]
v_cvt_pk_bf16_f32 v6, v232, v233
v_cvt_pk_bf16_f32 v7, v234, v235
v_cvt_pk_bf16_f32 v8, v236, v237
v_cvt_pk_bf16_f32 v9, v238, v239
s_mov_b32 s64, s66
v_permlane16_swap_b32 v2, v4
v_permlane16_swap_b32 v3, v5
buffer_store_dwordx4 v[2:5], v26, s[16:19], s64 offen offset:0 sc1
v_permlane16_swap_b32 v6, v8
v_permlane16_swap_b32 v7, v9
buffer_store_dwordx4 v[6:9], v27, s[16:19], s64 offen offset:1024 sc1
v_max_f32 v240, 0, v240
v_max_f32 v241, 0, v241
v_max_f32 v242, 0, v242
v_max_f32 v243, 0, v243
v_max_f32 v244, 0, v244
v_max_f32 v245, 0, v245
v_max_f32 v246, 0, v246
v_max_f32 v247, 0, v247
v_pk_mul_f32 v[240:241], v[240:241], v[240:241]
v_pk_mul_f32 v[242:243], v[242:243], v[242:243]
v_pk_mul_f32 v[244:245], v[244:245], v[244:245]
v_pk_mul_f32 v[246:247], v[246:247], v[246:247]
v_max_f32 v248, 0, v248
v_max_f32 v249, 0, v249
v_max_f32 v250, 0, v250
v_max_f32 v251, 0, v251
v_max_f32 v252, 0, v252
v_max_f32 v253, 0, v253
v_max_f32 v254, 0, v254
v_max_f32 v255, 0, v255
v_cvt_pk_bf16_f32 v10, v240, v241
v_cvt_pk_bf16_f32 v11, v242, v243
v_cvt_pk_bf16_f32 v12, v244, v245
v_cvt_pk_bf16_f32 v13, v246, v247
v_pk_mul_f32 v[248:249], v[248:249], v[248:249]
v_pk_mul_f32 v[250:251], v[250:251], v[250:251]
v_pk_mul_f32 v[252:253], v[252:253], v[252:253]
v_pk_mul_f32 v[254:255], v[254:255], v[254:255]
v_cvt_pk_bf16_f32 v14, v248, v249
v_cvt_pk_bf16_f32 v15, v250, v251
v_cvt_pk_bf16_f32 v16, v252, v253
v_cvt_pk_bf16_f32 v17, v254, v255
v_permlane16_swap_b32 v10, v12
v_permlane16_swap_b32 v11, v13
buffer_store_dwordx4 v[10:13], v28, s[16:19], s64 offen offset:2048 sc1
v_permlane16_swap_b32 v14, v16
v_permlane16_swap_b32 v15, v17
buffer_store_dwordx4 v[14:17], v29, s[16:19], s64 offen offset:3072 sc1
s_mov_b32 s41, 23626752
s_mov_b32 s52, 1
s_branch L_p3_entry
L_p3_entry:
s_and_b32 s60, s2, 7
s_cmp_ge_u32 s60, 4
s_cbranch_scc1 L_p3_final
s_mov_b32 s37, s31
s_load_dwordx2 s[4:5], s[0:1], 16
s_load_dwordx2 s[6:7], s[0:1], 48
s_load_dwordx2 s[54:55], s[0:1], 56
s_load_dwordx2 s[58:59], s[0:1], 72
s_and_b32 s60, s2, 3
s_lshr_b32 s61, s2, 3
s_lshl_b32 s60, s60, 2
s_lshr_b32 s63, s61, 3
s_add_u32 s34, s60, s63
s_and_b32 s35, s61, 7
s_lshl_b32 s36, s34, 3
s_add_u32 s36, s36, s35
s_lshl_b32 s40, s28, 12
v_lshlrev_b32 v1, 4, v0
v_lshrrev_b32 v20, 3, v0
v_lshlrev_b32 v20, 2, v20
s_mov_b32 s50, 286330880
v_bfe_u32 v17, s50, v20, 4
v_lshl_add_u32 v17, v17, 7, v1
s_mov_b32 s50, 572662289
v_bfe_u32 v18, s50, v20, 4
v_lshl_add_u32 v18, v18, 7, v1
s_mov_b32 s50, 858993458
v_bfe_u32 v19, s50, v20, 4
v_lshl_add_u32 v19, v19, 7, v1
s_mov_b32 s50, 1413760068
v_bfe_u32 v8, s50, v20, 4
v_lshl_add_u32 v8, v8, 7, v1
v_lshrrev_b32 v20, 3, v0
v_and_b32 v21, 7, v0
v_and_b32 v22, 2, v20
v_lshlrev_b32 v23, 11, v20
s_lshl_b32 s50, s28, 15
s_lshl_b32 s51, s35, 8
s_add_u32 s50, s50, s51
v_add_u32 v23, s50, v23
v_or_b32 v24, 0, v22
v_xor_b32 v24, v21, v24
v_lshlrev_b32 v24, 4, v24
v_add_u32 v24, v24, v23
v_add_u32 v2, 4096, v24
v_or_b32 v24, 0, v22
v_xor_b32 v24, v21, v24
v_lshlrev_b32 v24, 4, v24
v_add_u32 v24, v24, v23
v_add_u32 v3, 3200, v24
v_or_b32 v24, 4, v22
v_xor_b32 v24, v21, v24
v_lshlrev_b32 v24, 4, v24
v_add_u32 v24, v24, v23
v_add_u32 v4, 18432, v24
v_or_b32 v24, 4, v22
v_xor_b32 v24, v21, v24
v_lshlrev_b32 v24, 4, v24
v_add_u32 v24, v24, v23
v_add_u32 v5, 17536, v24
s_waitcnt lgkmcnt(0)
s_mov_b32 s8, s16
s_mov_b32 s9, s17
s_mov_b32 s10, 32112640
s_mov_b32 s11, 0x00020000
s_mov_b32 s20, s54
s_mov_b32 s21, s55
s_mov_b32 s22, 2048
s_mov_b32 s23, 0x00020000
s_mov_b32 s24, s58
s_mov_b32 s25, s59
s_mov_b32 s26, 4194304
s_mov_b32 s27, 0x00020000
s_sub_u32 s42, s6, 4096
s_subb_u32 s43, s7, 0
s_sub_u32 s12, s4, 4096
s_subb_u32 s13, s5, 0
s_mov_b32 s14, 2101248
s_mov_b32 s15, 0x00020000
s_mov_b32 s39, 0
s_mov_b32 s38, 0
s_mul_i32 s50, s34, 1474560
s_mul_i32 s51, s28, 5120
s_add_u32 s50, s50, s51
s_add_u32 s38, s38, s50
s_add_u32 s47, s50, 327680
s_mov_b32 s64, s100
s_mov_b32 s65, s101
s_mov_b32 s66, 256
s_mov_b32 s67, 0x00020000
v_mov_b32 v30, 0
buffer_load_dword v31, v30, s[64:67], 0 offen sc1
s_add_u32 m0, s40, 16384
s_nop 0
buffer_load_dwordx4 v2, s[12:15], s39 offen offset:0 lds
buffer_load_dwordx4 v3, s[12:15], s39 offen offset:1024 lds
buffer_load_dwordx4 v4, s[12:15], s39 offen offset:2048 lds
buffer_load_dwordx4 v5, s[12:15], s39 offen offset:3072 lds
s_add_u32 s39, s39, 131072
s_add_u32 m0, s40, 49152
s_nop 0
buffer_load_dwordx4 v2, s[12:15], s39 offen offset:0 lds
buffer_load_dwordx4 v3, s[12:15], s39 offen offset:1024 lds
buffer_load_dwordx4 v4, s[12:15], s39 offen offset:2048 lds
buffer_load_dwordx4 v5, s[12:15], s39 offen offset:3072 lds
s_add_u32 s39, s39, 131072
v_and_b32 v20, 15, v0
v_lshrrev_b32 v21, 4, v0
v_lshrrev_b32 v22, 1, v21
v_lshlrev_b32 v22, 12, v22
v_and_b32 v23, 1, v21
v_lshlrev_b32 v24, 9, v23
v_add_u32 v22, v22, v24
v_lshlrev_b32 v24, 4, v20
v_add_u32 v22, v22, v24
s_lshl_b32 s50, s29, 11
v_add_u32 v6, s50, v22
v_lshrrev_b32 v24, 2, v0
v_and_b32 v24, 3, v24
v_and_b32 v25, 3, v0
v_lshrrev_b32 v26, 1, v25
v_and_b32 v27, 2, v24
v_lshlrev_b32 v28, 2, v23
v_or_b32 v27, v27, v28
v_lshlrev_b32 v28, 11, v21
v_lshlrev_b32 v29, 7, v24
v_add_u32 v28, v28, v29
v_and_b32 v29, 1, v25
v_lshlrev_b32 v29, 3, v29
v_add_u32 v28, v28, v29
s_lshl_b32 s50, s30, 10
s_add_u32 s50, s50, 16384
v_add_u32 v28, s50, v28
v_or_b32 v29, 0, v26
v_xor_b32 v29, v29, v27
v_lshlrev_b32 v29, 4, v29
v_add_u32 v9, v28, v29
v_or_b32 v29, 2, v26
v_xor_b32 v29, v29, v27
v_lshlrev_b32 v29, 4, v29
v_add_u32 v10, v28, v29
v_or_b32 v29, 4, v26
v_xor_b32 v29, v29, v27
v_lshlrev_b32 v29, 4, v29
v_add_u32 v11, v28, v29
v_or_b32 v29, 6, v26
v_xor_b32 v29, v29, v27
v_lshlrev_b32 v29, 4, v29
v_add_u32 v12, v28, v29
v_add_u32 v7, 65536, v6
v_add_u32 v13, 65536, v9
v_add_u32 v14, 65536, v10
v_add_u32 v15, 65536, v11
v_add_u32 v16, 65536, v12
v_mov_b64 v[32:33], 0
v_mov_b64 v[34:35], 0
v_mov_b64 v[36:37], 0
v_mov_b64 v[38:39], 0
v_mov_b64 v[40:41], 0
v_mov_b64 v[42:43], 0
v_mov_b64 v[44:45], 0
v_mov_b64 v[46:47], 0
v_mov_b64 v[48:49], 0
v_mov_b64 v[50:51], 0
v_mov_b64 v[52:53], 0
v_mov_b64 v[54:55], 0
v_mov_b64 v[56:57], 0
v_mov_b64 v[58:59], 0
v_mov_b64 v[60:61], 0
v_mov_b64 v[62:63], 0
v_mov_b64 v[64:65], 0
v_mov_b64 v[66:67], 0
v_mov_b64 v[68:69], 0
v_mov_b64 v[70:71], 0
v_mov_b64 v[72:73], 0
v_mov_b64 v[74:75], 0
v_mov_b64 v[76:77], 0
v_mov_b64 v[78:79], 0
v_mov_b64 v[80:81], 0
v_mov_b64 v[82:83], 0
v_mov_b64 v[84:85], 0
v_mov_b64 v[86:87], 0
v_mov_b64 v[88:89], 0
v_mov_b64 v[90:91], 0
v_mov_b64 v[92:93], 0
v_mov_b64 v[94:95], 0
s_lshr_b32 s50, s34, 1
s_lshl_b32 s50, s50, 7
s_add_u32 s46, s50, 23625728
s_waitcnt vmcnt(8)
s_barrier
s_cmp_lg_u32 s28, 0
s_cbranch_scc1 L_p3_nopub_early
v_readfirstlane_b32 s63, v31
s_nop 3
s_cmp_ge_u32 s63, 256
s_cbranch_scc1 L_p3_initok_early
v_mov_b32 v30, 0
s_mov_b32 s62, 0
L_poll_init_early:
buffer_load_dword v29, v30, s[64:67], 0 offen sc1
s_waitcnt vmcnt(0)
v_readfirstlane_b32 s63, v29
s_nop 3
s_cmp_ge_u32 s63, 256
s_cbranch_scc1 L_got_init_early
s_add_u32 s62, s62, 1
s_cmp_lt_u32 s62, 20000
s_cbranch_scc0 L_got_init_early
s_sleep 1
s_branch L_poll_init_early
L_got_init_early:
L_p3_initok_early:
s_lshl_b32 s50, s37, 7
s_add_u32 s50, s50, s41
v_mov_b32 v29, 1
v_mov_b32 v30, 0
s_mov_b64 exec, 1
buffer_atomic_add v29, v30, s[16:19], s50 offen sc1
s_mov_b64 exec, -1
v_mov_b32 v30, 0
s_mov_b32 s62, 0
L_poll_cnt_early:
buffer_load_dword v29, v30, s[16:19], s46 offen sc1
s_waitcnt vmcnt(0)
v_readfirstlane_b32 s63, v29
s_nop 3
s_cmp_ge_u32 s63, 14
s_cbranch_scc1 L_got_cnt_early
s_add_u32 s62, s62, 1
s_cmp_lt_u32 s62, 20000
s_cbranch_scc0 L_got_cnt_early
s_sleep 1
s_branch L_poll_cnt_early
L_got_cnt_early:
L_p3_nopub_early:
s_barrier
s_add_u32 m0, s40, 0
s_nop 0
buffer_load_dwordx4 v17, s[8:11], s38 offen offset:0 lds
buffer_load_dwordx4 v18, s[8:11], s38 offen offset:1024 lds
buffer_load_dwordx4 v19, s[8:11], s38 offen offset:2048 lds
buffer_load_dwordx4 v8, s[8:11], s38 offen offset:3072 lds
s_add_u32 s38, s38, 20480
s_add_u32 m0, s40, 32768
s_nop 0
buffer_load_dwordx4 v17, s[8:11], s38 offen offset:0 lds
buffer_load_dwordx4 v18, s[8:11], s38 offen offset:1024 lds
buffer_load_dwordx4 v19, s[8:11], s38 offen offset:2048 lds
buffer_load_dwordx4 v8, s[8:11], s38 offen offset:3072 lds
s_add_u32 s38, s38, 20480
s_add_u32 m0, s40, 65536
s_nop 0
buffer_load_dwordx4 v17, s[8:11], s38 offen offset:0 lds
buffer_load_dwordx4 v18, s[8:11], s38 offen offset:1024 lds
buffer_load_dwordx4 v19, s[8:11], s38 offen offset:2048 lds
buffer_load_dwordx4 v8, s[8:11], s38 offen offset:3072 lds
s_add_u32 s38, s38, 40960
s_add_u32 m0, s40, 81920
s_nop 0
buffer_load_dwordx4 v2, s[12:15], s39 offen offset:0 lds
buffer_load_dwordx4 v3, s[12:15], s39 offen offset:1024 lds
buffer_load_dwordx4 v4, s[12:15], s39 offen offset:2048 lds
buffer_load_dwordx4 v5, s[12:15], s39 offen offset:3072 lds
s_add_u32 m0, s40, 98304
s_nop 0
buffer_load_dwordx4 v17, s[8:11], s38 offen offset:0 lds
buffer_load_dwordx4 v18, s[8:11], s38 offen offset:1024 lds
buffer_load_dwordx4 v19, s[8:11], s38 offen offset:2048 lds
buffer_load_dwordx4 v8, s[8:11], s38 offen offset:3072 lds
s_waitcnt vmcnt(16)
s_barrier
ds_read_b64_tr_b16 a[32:33], v9 offset:0
ds_read_b128 a[0:3], v6 offset:0
ds_read_b64_tr_b16 a[34:35], v9 offset:512
ds_read_b64_tr_b16 a[36:37], v10 offset:0
ds_read_b128 a[4:7], v6 offset:256
ds_read_b64_tr_b16 a[38:39], v10 offset:512
ds_read_b64_tr_b16 a[40:41], v11 offset:0
ds_read_b128 a[8:11], v6 offset:1024
ds_read_b64_tr_b16 a[42:43], v11 offset:512
ds_read_b64_tr_b16 a[44:45], v12 offset:0
ds_read_b128 a[12:15], v6 offset:1280
ds_read_b64_tr_b16 a[46:47], v12 offset:512
s_mov_b32 s33, 0
s_lshr_b32 s50, s34, 1
s_lshl_b32 s50, s50, 7
s_add_u32 s46, s50, 23626752
v_mov_b32 v30, 0
s_lshl_b32 s44, s36, 16
s_lshl_b32 s50, s28, 14
s_add_u32 s44, s44, s50
s_add_u32 s44, s44, 23658496
s_lshl_b32 s45, s36, 7
s_add_u32 s45, s45, 23642112
s_lshl_b32 s50, s28, 2
s_add_u32 s45, s45, s50
s_waitcnt lgkmcnt(0)
L_p3_loop_early:
s_cmp_eq_u32 s33, 2
s_cbranch_scc1 L_p3_sw_early
L_p3_sw_ret_early:
v_mfma_f32_16x16x32_bf16 v[32:35], a[32:35], a[0:3], v[32:35]
ds_read_b64_tr_b16 a[48:49], v9 offset:8192
s_cmp_eq_u32 s33, 0
s_cselect_b32 s49, 2, 1
s_cmp_eq_u32 s33, 1
s_cselect_b32 s49, -4, s49
s_mul_i32 s49, s49, 131072
v_mfma_f32_16x16x32_bf16 v[36:39], a[32:35], a[4:7], v[36:39]
ds_read_b128 a[16:19], v6 offset:8192
s_add_u32 s39, s39, s49
s_add_u32 m0, s40, 114688
v_mfma_f32_16x16x32_bf16 v[40:43], a[32:35], a[8:11], v[40:43]
ds_read_b64_tr_b16 a[50:51], v9 offset:8704
v_mfma_f32_16x16x32_bf16 v[44:47], a[32:35], a[12:15], v[44:47]
ds_read_b64_tr_b16 a[52:53], v10 offset:8192
v_mfma_f32_16x16x32_bf16 v[48:51], a[36:39], a[0:3], v[48:51]
ds_read_b128 a[20:23], v6 offset:8448
buffer_load_dwordx4 v2, s[12:15], s39 offen offset:0 lds
v_mfma_f32_16x16x32_bf16 v[52:55], a[36:39], a[4:7], v[52:55]
ds_read_b64_tr_b16 a[54:55], v10 offset:8704
v_mfma_f32_16x16x32_bf16 v[56:59], a[36:39], a[8:11], v[56:59]
ds_read_b64_tr_b16 a[56:57], v11 offset:8192
v_mfma_f32_16x16x32_bf16 v[60:63], a[36:39], a[12:15], v[60:63]
ds_read_b128 a[24:27], v6 offset:9216
buffer_load_dwordx4 v3, s[12:15], s39 offen offset:1024 lds
v_mfma_f32_16x16x32_bf16 v[64:67], a[40:43], a[0:3], v[64:67]
ds_read_b64_tr_b16 a[58:59], v11 offset:8704
v_mfma_f32_16x16x32_bf16 v[68:71], a[40:43], a[4:7], v[68:71]
ds_read_b64_tr_b16 a[60:61], v12 offset:8192
v_mfma_f32_16x16x32_bf16 v[72:75], a[40:43], a[8:11], v[72:75]
ds_read_b128 a[28:31], v6 offset:9472
buffer_load_dwordx4 v4, s[12:15], s39 offen offset:2048 lds
v_mfma_f32_16x16x32_bf16 v[76:79], a[40:43], a[12:15], v[76:79]
ds_read_b64_tr_b16 a[62:63], v12 offset:8704
v_mfma_f32_16x16x32_bf16 v[80:83], a[44:47], a[0:3], v[80:83]
v_mfma_f32_16x16x32_bf16 v[84:87], a[44:47], a[4:7], v[84:87]
buffer_load_dwordx4 v5, s[12:15], s39 offen offset:3072 lds
v_mfma_f32_16x16x32_bf16 v[88:91], a[44:47], a[8:11], v[88:91]
v_mfma_f32_16x16x32_bf16 v[92:95], a[44:47], a[12:15], v[92:95]
s_waitcnt vmcnt(16) lgkmcnt(0)
s_barrier
v_mfma_f32_16x16x32_bf16 v[32:35], a[48:51], a[16:19], v[32:35]
ds_read_b64_tr_b16 a[32:33], v9 offset:32768
s_add_u32 s38, s38, 20480
s_cmp_eq_u32 s33, 1
s_cselect_b32 s38, s47, s38
s_add_u32 m0, s40, 0
v_mfma_f32_16x16x32_bf16 v[36:39], a[48:51], a[20:23], v[36:39]
ds_read_b128 a[0:3], v6 offset:32768
v_mfma_f32_16x16x32_bf16 v[40:43], a[48:51], a[24:27], v[40:43]
ds_read_b64_tr_b16 a[34:35], v9 offset:33280
v_mfma_f32_16x16x32_bf16 v[44:47], a[48:51], a[28:31], v[44:47]
ds_read_b64_tr_b16 a[36:37], v10 offset:32768
v_mfma_f32_16x16x32_bf16 v[48:51], a[52:55], a[16:19], v[48:51]
ds_read_b128 a[4:7], v6 offset:33024
buffer_load_dwordx4 v17, s[8:11], s38 offen offset:0 lds
v_mfma_f32_16x16x32_bf16 v[52:55], a[52:55], a[20:23], v[52:55]
ds_read_b64_tr_b16 a[38:39], v10 offset:33280
v_mfma_f32_16x16x32_bf16 v[56:59], a[52:55], a[24:27], v[56:59]
ds_read_b64_tr_b16 a[40:41], v11 offset:32768
v_mfma_f32_16x16x32_bf16 v[60:63], a[52:55], a[28:31], v[60:63]
ds_read_b128 a[8:11], v6 offset:33792
buffer_load_dwordx4 v18, s[8:11], s38 offen offset:1024 lds
v_mfma_f32_16x16x32_bf16 v[64:67], a[56:59], a[16:19], v[64:67]
ds_read_b64_tr_b16 a[42:43], v11 offset:33280
v_mfma_f32_16x16x32_bf16 v[68:71], a[56:59], a[20:23], v[68:71]
ds_read_b64_tr_b16 a[44:45], v12 offset:32768
v_mfma_f32_16x16x32_bf16 v[72:75], a[56:59], a[24:27], v[72:75]
ds_read_b128 a[12:15], v6 offset:34048
buffer_load_dwordx4 v19, s[8:11], s38 offen offset:2048 lds
v_mfma_f32_16x16x32_bf16 v[76:79], a[56:59], a[28:31], v[76:79]
ds_read_b64_tr_b16 a[46:47], v12 offset:33280
v_mfma_f32_16x16x32_bf16 v[80:83], a[60:63], a[16:19], v[80:83]
v_mfma_f32_16x16x32_bf16 v[84:87], a[60:63], a[20:23], v[84:87]
buffer_load_dwordx4 v8, s[8:11], s38 offen offset:3072 lds
v_mfma_f32_16x16x32_bf16 v[88:91], a[60:63], a[24:27], v[88:91]
v_mfma_f32_16x16x32_bf16 v[92:95], a[60:63], a[28:31], v[92:95]
s_waitcnt lgkmcnt(0)
v_mfma_f32_16x16x32_bf16 v[32:35], a[32:35], a[0:3], v[32:35]
ds_read_b64_tr_b16 a[48:49], v9 offset:40960
s_add_u32 s39, s39, 131072
s_cmp_eq_u32 s33, 1
s_cselect_b32 s12, s42, s12
s_cselect_b32 s13, s43, s13
s_cselect_b32 s39, 0, s39
v_mfma_f32_16x16x32_bf16 v[36:39], a[32:35], a[4:7], v[36:39]
ds_read_b128 a[16:19], v6 offset:40960
s_cselect_b32 s14, 7344128, s14
s_add_u32 m0, s40, 16384
v_mfma_f32_16x16x32_bf16 v[40:43], a[32:35], a[8:11], v[40:43]
ds_read_b64_tr_b16 a[50:51], v9 offset:41472
v_mfma_f32_16x16x32_bf16 v[44:47], a[32:35], a[12:15], v[44:47]
ds_read_b64_tr_b16 a[52:53], v10 offset:40960
v_mfma_f32_16x16x32_bf16 v[48:51], a[36:39], a[0:3], v[48:51]
ds_read_b128 a[20:23], v6 offset:41216
buffer_load_dwordx4 v2, s[12:15], s39 offen offset:0 lds
v_mfma_f32_16x16x32_bf16 v[52:55], a[36:39], a[4:7], v[52:55]
ds_read_b64_tr_b16 a[54:55], v10 offset:41472
v_mfma_f32_16x16x32_bf16 v[56:59], a[36:39], a[8:11], v[56:59]
ds_read_b64_tr_b16 a[56:57], v11 offset:40960
v_mfma_f32_16x16x32_bf16 v[60:63], a[36:39], a[12:15], v[60:63]
ds_read_b128 a[24:27], v6 offset:41984
buffer_load_dwordx4 v3, s[12:15], s39 offen offset:1024 lds
v_mfma_f32_16x16x32_bf16 v[64:67], a[40:43], a[0:3], v[64:67]
ds_read_b64_tr_b16 a[58:59], v11 offset:41472
v_mfma_f32_16x16x32_bf16 v[68:71], a[40:43], a[4:7], v[68:71]
ds_read_b64_tr_b16 a[60:61], v12 offset:40960
v_mfma_f32_16x16x32_bf16 v[72:75], a[40:43], a[8:11], v[72:75]
ds_read_b128 a[28:31], v6 offset:42240
buffer_load_dwordx4 v4, s[12:15], s39 offen offset:2048 lds
v_mfma_f32_16x16x32_bf16 v[76:79], a[40:43], a[12:15], v[76:79]
ds_read_b64_tr_b16 a[62:63], v12 offset:41472
v_mfma_f32_16x16x32_bf16 v[80:83], a[44:47], a[0:3], v[80:83]
v_mfma_f32_16x16x32_bf16 v[84:87], a[44:47], a[4:7], v[84:87]
buffer_load_dwordx4 v5, s[12:15], s39 offen offset:3072 lds
v_mfma_f32_16x16x32_bf16 v[88:91], a[44:47], a[8:11], v[88:91]
v_mfma_f32_16x16x32_bf16 v[92:95], a[44:47], a[12:15], v[92:95]
s_waitcnt vmcnt(16) lgkmcnt(0)
s_barrier
v_mfma_f32_16x16x32_bf16 v[32:35], a[48:51], a[16:19], v[32:35]
ds_read_b64_tr_b16 a[32:33], v13 offset:0
s_add_u32 s38, s38, 20480
s_add_u32 m0, s40, 32768
v_mfma_f32_16x16x32_bf16 v[36:39], a[48:51], a[20:23], v[36:39]
ds_read_b128 a[0:3], v7 offset:0
v_mfma_f32_16x16x32_bf16 v[40:43], a[48:51], a[24:27], v[40:43]
ds_read_b64_tr_b16 a[34:35], v13 offset:512
v_mfma_f32_16x16x32_bf16 v[44:47], a[48:51], a[28:31], v[44:47]
ds_read_b64_tr_b16 a[36:37], v14 offset:0
v_mfma_f32_16x16x32_bf16 v[48:51], a[52:55], a[16:19], v[48:51]
ds_read_b128 a[4:7], v7 offset:256
buffer_load_dwordx4 v17, s[8:11], s38 offen offset:0 lds
v_mfma_f32_16x16x32_bf16 v[52:55], a[52:55], a[20:23], v[52:55]
ds_read_b64_tr_b16 a[38:39], v14 offset:512
v_mfma_f32_16x16x32_bf16 v[56:59], a[52:55], a[24:27], v[56:59]
ds_read_b64_tr_b16 a[40:41], v15 offset:0
v_mfma_f32_16x16x32_bf16 v[60:63], a[52:55], a[28:31], v[60:63]
ds_read_b128 a[8:11], v7 offset:1024
buffer_load_dwordx4 v18, s[8:11], s38 offen offset:1024 lds
v_mfma_f32_16x16x32_bf16 v[64:67], a[56:59], a[16:19], v[64:67]
ds_read_b64_tr_b16 a[42:43], v15 offset:512
v_mfma_f32_16x16x32_bf16 v[68:71], a[56:59], a[20:23], v[68:71]
ds_read_b64_tr_b16 a[44:45], v16 offset:0
v_mfma_f32_16x16x32_bf16 v[72:75], a[56:59], a[24:27], v[72:75]
ds_read_b128 a[12:15], v7 offset:1280
buffer_load_dwordx4 v19, s[8:11], s38 offen offset:2048 lds
v_mfma_f32_16x16x32_bf16 v[76:79], a[56:59], a[28:31], v[76:79]
ds_read_b64_tr_b16 a[46:47], v16 offset:512
v_mfma_f32_16x16x32_bf16 v[80:83], a[60:63], a[16:19], v[80:83]
v_mfma_f32_16x16x32_bf16 v[84:87], a[60:63], a[20:23], v[84:87]
buffer_load_dwordx4 v8, s[8:11], s38 offen offset:3072 lds
v_mfma_f32_16x16x32_bf16 v[88:91], a[60:63], a[24:27], v[88:91]
v_mfma_f32_16x16x32_bf16 v[92:95], a[60:63], a[28:31], v[92:95]
s_waitcnt lgkmcnt(0)
s_cmp_eq_u32 s33, 8
s_cbranch_scc1 L_p3_tail_early
v_mfma_f32_16x16x32_bf16 v[32:35], a[32:35], a[0:3], v[32:35]
ds_read_b64_tr_b16 a[48:49], v13 offset:8192
s_add_u32 s39, s39, 131072
s_add_u32 m0, s40, 49152
v_mfma_f32_16x16x32_bf16 v[36:39], a[32:35], a[4:7], v[36:39]
ds_read_b128 a[16:19], v7 offset:8192
v_mfma_f32_16x16x32_bf16 v[40:43], a[32:35], a[8:11], v[40:43]
ds_read_b64_tr_b16 a[50:51], v13 offset:8704
v_mfma_f32_16x16x32_bf16 v[44:47], a[32:35], a[12:15], v[44:47]
ds_read_b64_tr_b16 a[52:53], v14 offset:8192
v_mfma_f32_16x16x32_bf16 v[48:51], a[36:39], a[0:3], v[48:51]
ds_read_b128 a[20:23], v7 offset:8448
buffer_load_dwordx4 v2, s[12:15], s39 offen offset:0 lds
v_mfma_f32_16x16x32_bf16 v[52:55], a[36:39], a[4:7], v[52:55]
ds_read_b64_tr_b16 a[54:55], v14 offset:8704
v_mfma_f32_16x16x32_bf16 v[56:59], a[36:39], a[8:11], v[56:59]
ds_read_b64_tr_b16 a[56:57], v15 offset:8192
v_mfma_f32_16x16x32_bf16 v[60:63], a[36:39], a[12:15], v[60:63]
ds_read_b128 a[24:27], v7 offset:9216
buffer_load_dwordx4 v3, s[12:15], s39 offen offset:1024 lds
v_mfma_f32_16x16x32_bf16 v[64:67], a[40:43], a[0:3], v[64:67]
ds_read_b64_tr_b16 a[58:59], v15 offset:8704
v_mfma_f32_16x16x32_bf16 v[68:71], a[40:43], a[4:7], v[68:71]
ds_read_b64_tr_b16 a[60:61], v16 offset:8192
v_mfma_f32_16x16x32_bf16 v[72:75], a[40:43], a[8:11], v[72:75]
ds_read_b128 a[28:31], v7 offset:9472
buffer_load_dwordx4 v4, s[12:15], s39 offen offset:2048 lds
v_mfma_f32_16x16x32_bf16 v[76:79], a[40:43], a[12:15], v[76:79]
ds_read_b64_tr_b16 a[62:63], v16 offset:8704
v_mfma_f32_16x16x32_bf16 v[80:83], a[44:47], a[0:3], v[80:83]
v_mfma_f32_16x16x32_bf16 v[84:87], a[44:47], a[4:7], v[84:87]
buffer_load_dwordx4 v5, s[12:15], s39 offen offset:3072 lds
v_mfma_f32_16x16x32_bf16 v[88:91], a[44:47], a[8:11], v[88:91]
v_mfma_f32_16x16x32_bf16 v[92:95], a[44:47], a[12:15], v[92:95]
s_cmp_eq_u32 s33, 0
s_cbranch_scc0 L_p3_nopf_early
buffer_load_dword v29, v30, s[16:19], s46 offen sc1
L_p3_nopf_early:
s_waitcnt vmcnt(16) lgkmcnt(0)
s_barrier
v_mfma_f32_16x16x32_bf16 v[32:35], a[48:51], a[16:19], v[32:35]
ds_read_b64_tr_b16 a[32:33], v13 offset:32768
s_add_u32 s38, s38, 20480
s_cmp_eq_u32 s33, 7
s_cselect_b32 s10, 0, s10
s_add_u32 m0, s40, 65536
v_mfma_f32_16x16x32_bf16 v[36:39], a[48:51], a[20:23], v[36:39]
ds_read_b128 a[0:3], v7 offset:32768
v_mfma_f32_16x16x32_bf16 v[40:43], a[48:51], a[24:27], v[40:43]
ds_read_b64_tr_b16 a[34:35], v13 offset:33280
v_mfma_f32_16x16x32_bf16 v[44:47], a[48:51], a[28:31], v[44:47]
ds_read_b64_tr_b16 a[36:37], v14 offset:32768
v_mfma_f32_16x16x32_bf16 v[48:51], a[52:55], a[16:19], v[48:51]
ds_read_b128 a[4:7], v7 offset:33024
buffer_load_dwordx4 v17, s[8:11], s38 offen offset:0 lds
v_mfma_f32_16x16x32_bf16 v[52:55], a[52:55], a[20:23], v[52:55]
ds_read_b64_tr_b16 a[38:39], v14 offset:33280
v_mfma_f32_16x16x32_bf16 v[56:59], a[52:55], a[24:27], v[56:59]
ds_read_b64_tr_b16 a[40:41], v15 offset:32768
v_mfma_f32_16x16x32_bf16 v[60:63], a[52:55], a[28:31], v[60:63]
ds_read_b128 a[8:11], v7 offset:33792
buffer_load_dwordx4 v18, s[8:11], s38 offen offset:1024 lds
v_mfma_f32_16x16x32_bf16 v[64:67], a[56:59], a[16:19], v[64:67]
ds_read_b64_tr_b16 a[42:43], v15 offset:33280
v_mfma_f32_16x16x32_bf16 v[68:71], a[56:59], a[20:23], v[68:71]
ds_read_b64_tr_b16 a[44:45], v16 offset:32768
v_mfma_f32_16x16x32_bf16 v[72:75], a[56:59], a[24:27], v[72:75]
ds_read_b128 a[12:15], v7 offset:34048
buffer_load_dwordx4 v19, s[8:11], s38 offen offset:2048 lds
v_mfma_f32_16x16x32_bf16 v[76:79], a[56:59], a[28:31], v[76:79]
ds_read_b64_tr_b16 a[46:47], v16 offset:33280
v_mfma_f32_16x16x32_bf16 v[80:83], a[60:63], a[16:19], v[80:83]
v_mfma_f32_16x16x32_bf16 v[84:87], a[60:63], a[20:23], v[84:87]
buffer_load_dwordx4 v8, s[8:11], s38 offen offset:3072 lds
v_mfma_f32_16x16x32_bf16 v[88:91], a[60:63], a[24:27], v[88:91]
v_mfma_f32_16x16x32_bf16 v[92:95], a[60:63], a[28:31], v[92:95]
s_waitcnt lgkmcnt(0)
v_mfma_f32_16x16x32_bf16 v[32:35], a[32:35], a[0:3], v[32:35]
ds_read_b64_tr_b16 a[48:49], v13 offset:40960
s_add_u32 s39, s39, 131072
s_cmp_eq_u32 s33, 7
s_cselect_b32 s14, 0, s14
s_add_u32 m0, s40, 81920
v_mfma_f32_16x16x32_bf16 v[36:39], a[32:35], a[4:7], v[36:39]
ds_read_b128 a[16:19], v7 offset:40960
v_mfma_f32_16x16x32_bf16 v[40:43], a[32:35], a[8:11], v[40:43]
ds_read_b64_tr_b16 a[50:51], v13 offset:41472
v_mfma_f32_16x16x32_bf16 v[44:47], a[32:35], a[12:15], v[44:47]
ds_read_b64_tr_b16 a[52:53], v14 offset:40960
v_mfma_f32_16x16x32_bf16 v[48:51], a[36:39], a[0:3], v[48:51]
ds_read_b128 a[20:23], v7 offset:41216
buffer_load_dwordx4 v2, s[12:15], s39 offen offset:0 lds
v_mfma_f32_16x16x32_bf16 v[52:55], a[36:39], a[4:7], v[52:55]
ds_read_b64_tr_b16 a[54:55], v14 offset:41472
v_mfma_f32_16x16x32_bf16 v[56:59], a[36:39], a[8:11], v[56:59]
ds_read_b64_tr_b16 a[56:57], v15 offset:40960
v_mfma_f32_16x16x32_bf16 v[60:63], a[36:39], a[12:15], v[60:63]
ds_read_b128 a[24:27], v7 offset:41984
buffer_load_dwordx4 v3, s[12:15], s39 offen offset:1024 lds
v_mfma_f32_16x16x32_bf16 v[64:67], a[40:43], a[0:3], v[64:67]
ds_read_b64_tr_b16 a[58:59], v15 offset:41472
v_mfma_f32_16x16x32_bf16 v[68:71], a[40:43], a[4:7], v[68:71]
ds_read_b64_tr_b16 a[60:61], v16 offset:40960
v_mfma_f32_16x16x32_bf16 v[72:75], a[40:43], a[8:11], v[72:75]
ds_read_b128 a[28:31], v7 offset:42240
buffer_load_dwordx4 v4, s[12:15], s39 offen offset:2048 lds
v_mfma_f32_16x16x32_bf16 v[76:79], a[40:43], a[12:15], v[76:79]
ds_read_b64_tr_b16 a[62:63], v16 offset:41472
v_mfma_f32_16x16x32_bf16 v[80:83], a[44:47], a[0:3], v[80:83]
v_mfma_f32_16x16x32_bf16 v[84:87], a[44:47], a[4:7], v[84:87]
buffer_load_dwordx4 v5, s[12:15], s39 offen offset:3072 lds
v_mfma_f32_16x16x32_bf16 v[88:91], a[44:47], a[8:11], v[88:91]
v_mfma_f32_16x16x32_bf16 v[92:95], a[44:47], a[12:15], v[92:95]
s_waitcnt vmcnt(16) lgkmcnt(0)
s_barrier
s_cmp_eq_u32 s33, 0
s_cbranch_scc1 L_p3_chk_early
L_p3_chk_ret_early:
v_mfma_f32_16x16x32_bf16 v[32:35], a[48:51], a[16:19], v[32:35]
ds_read_b64_tr_b16 a[32:33], v9 offset:0
s_cmp_eq_u32 s33, 0
s_cselect_b32 s49, -4, 1
s_mul_i32 s49, s49, 20480
s_add_u32 s38, s38, s49
s_add_u32 m0, s40, 98304
v_mfma_f32_16x16x32_bf16 v[36:39], a[48:51], a[20:23], v[36:39]
ds_read_b128 a[0:3], v6 offset:0
v_mfma_f32_16x16x32_bf16 v[40:43], a[48:51], a[24:27], v[40:43]
ds_read_b64_tr_b16 a[34:35], v9 offset:512
v_mfma_f32_16x16x32_bf16 v[44:47], a[48:51], a[28:31], v[44:47]
ds_read_b64_tr_b16 a[36:37], v10 offset:0
v_mfma_f32_16x16x32_bf16 v[48:51], a[52:55], a[16:19], v[48:51]
ds_read_b128 a[4:7], v6 offset:256
buffer_load_dwordx4 v17, s[8:11], s38 offen offset:0 lds
v_mfma_f32_16x16x32_bf16 v[52:55], a[52:55], a[20:23], v[52:55]
ds_read_b64_tr_b16 a[38:39], v10 offset:512
v_mfma_f32_16x16x32_bf16 v[56:59], a[52:55], a[24:27], v[56:59]
ds_read_b64_tr_b16 a[40:41], v11 offset:0
v_mfma_f32_16x16x32_bf16 v[60:63], a[52:55], a[28:31], v[60:63]
ds_read_b128 a[8:11], v6 offset:1024
buffer_load_dwordx4 v18, s[8:11], s38 offen offset:1024 lds
v_mfma_f32_16x16x32_bf16 v[64:67], a[56:59], a[16:19], v[64:67]
ds_read_b64_tr_b16 a[42:43], v11 offset:512
v_mfma_f32_16x16x32_bf16 v[68:71], a[56:59], a[20:23], v[68:71]
ds_read_b64_tr_b16 a[44:45], v12 offset:0
v_mfma_f32_16x16x32_bf16 v[72:75], a[56:59], a[24:27], v[72:75]
ds_read_b128 a[12:15], v6 offset:1280
buffer_load_dwordx4 v19, s[8:11], s38 offen offset:2048 lds
v_mfma_f32_16x16x32_bf16 v[76:79], a[56:59], a[28:31], v[76:79]
ds_read_b64_tr_b16 a[46:47], v12 offset:512
v_mfma_f32_16x16x32_bf16 v[80:83], a[60:63], a[16:19], v[80:83]
v_mfma_f32_16x16x32_bf16 v[84:87], a[60:63], a[20:23], v[84:87]
buffer_load_dwordx4 v8, s[8:11], s38 offen offset:3072 lds
v_mfma_f32_16x16x32_bf16 v[88:91], a[60:63], a[24:27], v[88:91]
v_mfma_f32_16x16x32_bf16 v[92:95], a[60:63], a[28:31], v[92:95]
s_waitcnt lgkmcnt(0)
s_add_u32 s33, s33, 1
s_branch L_p3_loop_early
L_p3_sw_early:
s_nop 7
v_sub_f32 v25, 1.0, v21
v_cvt_pk_bf16_f32 v25, v25, v25
v_lshlrev_b32 v25, 16, v25
v_sub_f32 v26, 1.0, v22
v_cvt_pk_bf16_f32 v26, v26, v26
v_lshlrev_b32 v26, 16, v26
v_sub_f32 v27, 1.0, v23
v_cvt_pk_bf16_f32 v27, v27, v27
v_lshlrev_b32 v27, 16, v27
v_sub_f32 v28, 1.0, v24
v_cvt_pk_bf16_f32 v28, v28, v28
v_lshlrev_b32 v28, 16, v28
v_pk_mul_f32 v[96:97], v[32:33], v[20:21] op_sel:[0,1] op_sel_hi:[1,1]
v_pk_mul_f32 v[98:99], v[34:35], v[20:21] op_sel:[0,1] op_sel_hi:[1,1]
v_pk_mul_f32 v[100:101], v[36:37], v[22:23] op_sel:[0,0] op_sel_hi:[1,0]
v_pk_mul_f32 v[102:103], v[38:39], v[22:23] op_sel:[0,0] op_sel_hi:[1,0]
v_pk_mul_f32 v[104:105], v[40:41], v[22:23] op_sel:[0,1] op_sel_hi:[1,1]
v_pk_mul_f32 v[106:107], v[42:43], v[22:23] op_sel:[0,1] op_sel_hi:[1,1]
v_pk_mul_f32 v[108:109], v[44:45], v[24:25] op_sel:[0,0] op_sel_hi:[1,0]
v_pk_mul_f32 v[110:111], v[46:47], v[24:25] op_sel:[0,0] op_sel_hi:[1,0]
v_pk_mul_f32 v[112:113], v[48:49], v[20:21] op_sel:[0,1] op_sel_hi:[1,1]
v_pk_mul_f32 v[114:115], v[50:51], v[20:21] op_sel:[0,1] op_sel_hi:[1,1]
v_pk_mul_f32 v[116:117], v[52:53], v[22:23] op_sel:[0,0] op_sel_hi:[1,0]
v_pk_mul_f32 v[118:119], v[54:55], v[22:23] op_sel:[0,0] op_sel_hi:[1,0]
v_pk_mul_f32 v[120:121], v[56:57], v[22:23] op_sel:[0,1] op_sel_hi:[1,1]
v_pk_mul_f32 v[122:123], v[58:59], v[22:23] op_sel:[0,1] op_sel_hi:[1,1]
v_pk_mul_f32 v[124:125], v[60:61], v[24:25] op_sel:[0,0] op_sel_hi:[1,0]
v_pk_mul_f32 v[126:127], v[62:63], v[24:25] op_sel:[0,0] op_sel_hi:[1,0]
v_pk_mul_f32 v[128:129], v[64:65], v[20:21] op_sel:[0,1] op_sel_hi:[1,1]
v_pk_mul_f32 v[130:131], v[66:67], v[20:21] op_sel:[0,1] op_sel_hi:[1,1]
v_pk_mul_f32 v[132:133], v[68:69], v[22:23] op_sel:[0,0] op_sel_hi:[1,0]
v_pk_mul_f32 v[134:135], v[70:71], v[22:23] op_sel:[0,0] op_sel_hi:[1,0]
v_pk_mul_f32 v[136:137], v[72:73], v[22:23] op_sel:[0,1] op_sel_hi:[1,1]
v_pk_mul_f32 v[138:139], v[74:75], v[22:23] op_sel:[0,1] op_sel_hi:[1,1]
v_pk_mul_f32 v[140:141], v[76:77], v[24:25] op_sel:[0,0] op_sel_hi:[1,0]
v_pk_mul_f32 v[142:143], v[78:79], v[24:25] op_sel:[0,0] op_sel_hi:[1,0]
v_pk_mul_f32 v[144:145], v[80:81], v[20:21] op_sel:[0,1] op_sel_hi:[1,1]
v_pk_mul_f32 v[146:147], v[82:83], v[20:21] op_sel:[0,1] op_sel_hi:[1,1]
v_pk_mul_f32 v[148:149], v[84:85], v[22:23] op_sel:[0,0] op_sel_hi:[1,0]
v_pk_mul_f32 v[150:151], v[86:87], v[22:23] op_sel:[0,0] op_sel_hi:[1,0]
v_pk_mul_f32 v[152:153], v[88:89], v[22:23] op_sel:[0,1] op_sel_hi:[1,1]
v_pk_mul_f32 v[154:155], v[90:91], v[22:23] op_sel:[0,1] op_sel_hi:[1,1]
v_pk_mul_f32 v[156:157], v[92:93], v[24:25] op_sel:[0,0] op_sel_hi:[1,0]
v_pk_mul_f32 v[158:159], v[94:95], v[24:25] op_sel:[0,0] op_sel_hi:[1,0]
v_mov_b64 v[32:33], 0
v_mov_b64 v[34:35], 0
v_mov_b64 v[36:37], 0
v_mov_b64 v[38:39], 0
v_mov_b64 v[40:41], 0
v_mov_b64 v[42:43], 0
v_mov_b64 v[44:45], 0
v_mov_b64 v[46:47], 0
v_mov_b64 v[48:49], 0
v_mov_b64 v[50:51], 0
v_mov_b64 v[52:53], 0
v_mov_b64 v[54:55], 0
v_mov_b64 v[56:57], 0
v_mov_b64 v[58:59], 0
v_mov_b64 v[60:61], 0
v_mov_b64 v[62:63], 0
v_mov_b64 v[64:65], 0
v_mov_b64 v[66:67], 0
v_mov_b64 v[68:69], 0
v_mov_b64 v[70:71], 0
v_mov_b64 v[72:73], 0
v_mov_b64 v[74:75], 0
v_mov_b64 v[76:77], 0
v_mov_b64 v[78:79], 0
v_mov_b64 v[80:81], 0
v_mov_b64 v[82:83], 0
v_mov_b64 v[84:85], 0
v_mov_b64 v[86:87], 0
v_mov_b64 v[88:89], 0
v_mov_b64 v[90:91], 0
v_mov_b64 v[92:93], 0
v_mov_b64 v[94:95], 0
s_nop 1
s_branch L_p3_sw_ret_early
L_p3_chk_early:
s_waitcnt vmcnt(8)
v_readfirstlane_b32 s63, v29
s_nop 3
s_cmp_ge_u32 s63, 18
s_cbranch_scc1 L_p3_chk_ok_early
v_mov_b32 v30, 0
s_mov_b32 s62, 0
L_poll_late_early:
buffer_load_dword v29, v30, s[16:19], s46 offen sc1
s_waitcnt vmcnt(0)
v_readfirstlane_b32 s63, v29
s_nop 3
s_cmp_ge_u32 s63, 18
s_cbranch_scc1 L_got_late_early
s_add_u32 s62, s62, 1
s_cmp_lt_u32 s62, 20000
s_cbranch_scc0 L_got_late_early
s_sleep 1
s_branch L_poll_late_early
L_got_late_early:
L_p3_chk_ok_early:
v_and_b32 v29, 15, v0
v_lshrrev_b32 v30, 3, v29
v_lshlrev_b32 v30, 7, v30
v_and_b32 v29, 7, v29
v_lshlrev_b32 v29, 3, v29
v_add_u32 v29, v29, v30
s_lshl_b32 s50, s34, 10
s_lshl_b32 s51, s29, 9
s_add_u32 s50, s50, s51
s_add_u32 s50, s50, 23592960
buffer_load_dword v21, v29, s[16:19], s50 offen offset:0 sc1
buffer_load_dword v22, v29, s[16:19], s50 offen offset:4 sc1
buffer_load_dword v23, v29, s[16:19], s50 offen offset:256 sc1
buffer_load_dword v24, v29, s[16:19], s50 offen offset:260 sc1
v_mov_b32 v30, 0
s_branch L_p3_chk_ret_early
L_p3_tail_early:
L_p3_done_early:
s_waitcnt vmcnt(0)
s_nop 7
v_pk_fma_f32 v[96:97], v[32:33], v[24:25], v[96:97] op_sel:[0,1,0] op_sel_hi:[1,1,1]
v_pk_fma_f32 v[98:99], v[34:35], v[24:25], v[98:99] op_sel:[0,1,0] op_sel_hi:[1,1,1]
v_pk_fma_f32 v[100:101], v[36:37], v[26:27], v[100:101] op_sel:[0,0,0] op_sel_hi:[1,0,1]
v_pk_fma_f32 v[102:103], v[38:39], v[26:27], v[102:103] op_sel:[0,0,0] op_sel_hi:[1,0,1]
v_cvt_pk_bf16_f32 v160, v96, v97
v_cvt_pk_bf16_f32 v161, v98, v99
v_cvt_pk_bf16_f32 v162, v100, v101
v_cvt_pk_bf16_f32 v163, v102, v103
s_add_u32 s50, s44, 0
buffer_store_dwordx4 v[160:163], v1, s[16:19], s50 offen offset:0 sc1
v_pk_fma_f32 v[104:105], v[40:41], v[26:27], v[104:105] op_sel:[0,1,0] op_sel_hi:[1,1,1]
v_pk_fma_f32 v[106:107], v[42:43], v[26:27], v[106:107] op_sel:[0,1,0] op_sel_hi:[1,1,1]
v_pk_fma_f32 v[108:109], v[44:45], v[28:29], v[108:109] op_sel:[0,0,0] op_sel_hi:[1,0,1]
v_pk_fma_f32 v[110:111], v[46:47], v[28:29], v[110:111] op_sel:[0,0,0] op_sel_hi:[1,0,1]
v_cvt_pk_bf16_f32 v164, v104, v105
v_cvt_pk_bf16_f32 v165, v106, v107
v_cvt_pk_bf16_f32 v166, v108, v109
v_cvt_pk_bf16_f32 v167, v110, v111
buffer_store_dwordx4 v[164:167], v1, s[16:19], s50 offen offset:1024 sc1
v_pk_fma_f32 v[112:113], v[48:49], v[24:25], v[112:113] op_sel:[0,1,0] op_sel_hi:[1,1,1]
v_pk_fma_f32 v[114:115], v[50:51], v[24:25], v[114:115] op_sel:[0,1,0] op_sel_hi:[1,1,1]
v_pk_fma_f32 v[116:117], v[52:53], v[26:27], v[116:117] op_sel:[0,0,0] op_sel_hi:[1,0,1]
v_pk_fma_f32 v[118:119], v[54:55], v[26:27], v[118:119] op_sel:[0,0,0] op_sel_hi:[1,0,1]
v_cvt_pk_bf16_f32 v168, v112, v113
v_cvt_pk_bf16_f32 v169, v114, v115
v_cvt_pk_bf16_f32 v170, v116, v117
v_cvt_pk_bf16_f32 v171, v118, v119
buffer_store_dwordx4 v[168:171], v1, s[16:19], s50 offen offset:2048 sc1
v_pk_fma_f32 v[120:121], v[56:57], v[26:27], v[120:121] op_sel:[0,1,0] op_sel_hi:[1,1,1]
v_pk_fma_f32 v[122:123], v[58:59], v[26:27], v[122:123] op_sel:[0,1,0] op_sel_hi:[1,1,1]
v_pk_fma_f32 v[124:125], v[60:61], v[28:29], v[124:125] op_sel:[0,0,0] op_sel_hi:[1,0,1]
v_pk_fma_f32 v[126:127], v[62:63], v[28:29], v[126:127] op_sel:[0,0,0] op_sel_hi:[1,0,1]
v_cvt_pk_bf16_f32 v172, v120, v121
v_cvt_pk_bf16_f32 v173, v122, v123
v_cvt_pk_bf16_f32 v174, v124, v125
v_cvt_pk_bf16_f32 v175, v126, v127
buffer_store_dwordx4 v[172:175], v1, s[16:19], s50 offen offset:3072 sc1
v_pk_fma_f32 v[128:129], v[64:65], v[24:25], v[128:129] op_sel:[0,1,0] op_sel_hi:[1,1,1]
v_pk_fma_f32 v[130:131], v[66:67], v[24:25], v[130:131] op_sel:[0,1,0] op_sel_hi:[1,1,1]
v_pk_fma_f32 v[132:133], v[68:69], v[26:27], v[132:133] op_sel:[0,0,0] op_sel_hi:[1,0,1]
v_pk_fma_f32 v[134:135], v[70:71], v[26:27], v[134:135] op_sel:[0,0,0] op_sel_hi:[1,0,1]
v_cvt_pk_bf16_f32 v176, v128, v129
v_cvt_pk_bf16_f32 v177, v130, v131
v_cvt_pk_bf16_f32 v178, v132, v133
v_cvt_pk_bf16_f32 v179, v134, v135
s_add_u32 s50, s44, 4096
buffer_store_dwordx4 v[176:179], v1, s[16:19], s50 offen offset:0 sc1
v_pk_fma_f32 v[136:137], v[72:73], v[26:27], v[136:137] op_sel:[0,1,0] op_sel_hi:[1,1,1]
v_pk_fma_f32 v[138:139], v[74:75], v[26:27], v[138:139] op_sel:[0,1,0] op_sel_hi:[1,1,1]
v_pk_fma_f32 v[140:141], v[76:77], v[28:29], v[140:141] op_sel:[0,0,0] op_sel_hi:[1,0,1]
v_pk_fma_f32 v[142:143], v[78:79], v[28:29], v[142:143] op_sel:[0,0,0] op_sel_hi:[1,0,1]
v_cvt_pk_bf16_f32 v180, v136, v137
v_cvt_pk_bf16_f32 v181, v138, v139
v_cvt_pk_bf16_f32 v182, v140, v141
v_cvt_pk_bf16_f32 v183, v142, v143
buffer_store_dwordx4 v[180:183], v1, s[16:19], s50 offen offset:1024 sc1
v_pk_fma_f32 v[144:145], v[80:81], v[24:25], v[144:145] op_sel:[0,1,0] op_sel_hi:[1,1,1]
v_pk_fma_f32 v[146:147], v[82:83], v[24:25], v[146:147] op_sel:[0,1,0] op_sel_hi:[1,1,1]
v_pk_fma_f32 v[148:149], v[84:85], v[26:27], v[148:149] op_sel:[0,0,0] op_sel_hi:[1,0,1]
v_pk_fma_f32 v[150:151], v[86:87], v[26:27], v[150:151] op_sel:[0,0,0] op_sel_hi:[1,0,1]
v_cvt_pk_bf16_f32 v184, v144, v145
v_cvt_pk_bf16_f32 v185, v146, v147
v_cvt_pk_bf16_f32 v186, v148, v149
v_cvt_pk_bf16_f32 v187, v150, v151
buffer_store_dwordx4 v[184:187], v1, s[16:19], s50 offen offset:2048 sc1
v_pk_fma_f32 v[152:153], v[88:89], v[26:27], v[152:153] op_sel:[0,1,0] op_sel_hi:[1,1,1]
v_pk_fma_f32 v[154:155], v[90:91], v[26:27], v[154:155] op_sel:[0,1,0] op_sel_hi:[1,1,1]
v_pk_fma_f32 v[156:157], v[92:93], v[28:29], v[156:157] op_sel:[0,0,0] op_sel_hi:[1,0,1]
v_pk_fma_f32 v[158:159], v[94:95], v[28:29], v[158:159] op_sel:[0,0,0] op_sel_hi:[1,0,1]
v_cvt_pk_bf16_f32 v188, v152, v153
v_cvt_pk_bf16_f32 v189, v154, v155
v_cvt_pk_bf16_f32 v190, v156, v157
v_cvt_pk_bf16_f32 v191, v158, v159
buffer_store_dwordx4 v[188:191], v1, s[16:19], s50 offen offset:3072 sc1
s_waitcnt vmcnt(0)
v_mov_b32 v20, 1
v_mov_b32 v21, 0
v_cmp_eq_u32 vcc, 0, v0
s_nop 0
s_and_saveexec_b64 s[60:61], vcc
buffer_store_dword v20, v21, s[16:19], s45 offen sc1
s_mov_b64 exec, s[60:61]
s_branch L_fin
L_p3_final:
s_mov_b32 s37, s31
s_load_dwordx2 s[4:5], s[0:1], 16
s_load_dwordx2 s[6:7], s[0:1], 48
s_load_dwordx2 s[54:55], s[0:1], 56
s_load_dwordx2 s[58:59], s[0:1], 72
s_and_b32 s60, s2, 3
s_lshr_b32 s61, s2, 3
s_lshl_b32 s60, s60, 2
s_lshr_b32 s63, s61, 3
s_add_u32 s34, s60, s63
s_and_b32 s35, s61, 7
s_lshl_b32 s36, s34, 3
s_add_u32 s36, s36, s35
s_lshl_b32 s40, s28, 12
v_lshlrev_b32 v1, 4, v0
v_lshrrev_b32 v20, 3, v0
v_lshlrev_b32 v20, 2, v20
s_mov_b32 s50, 286330880
v_bfe_u32 v17, s50, v20, 4
v_lshl_add_u32 v17, v17, 7, v1
s_mov_b32 s50, 572662289
v_bfe_u32 v18, s50, v20, 4
v_lshl_add_u32 v18, v18, 7, v1
s_mov_b32 s50, 858993458
v_bfe_u32 v19, s50, v20, 4
v_lshl_add_u32 v19, v19, 7, v1
s_mov_b32 s50, 1413760068
v_bfe_u32 v8, s50, v20, 4
v_lshl_add_u32 v8, v8, 7, v1
v_lshrrev_b32 v20, 3, v0
v_and_b32 v21, 7, v0
v_and_b32 v22, 2, v20
v_lshlrev_b32 v23, 11, v20
s_lshl_b32 s50, s28, 15
s_lshl_b32 s51, s35, 8
s_add_u32 s50, s50, s51
v_add_u32 v23, s50, v23
v_or_b32 v24, 0, v22
v_xor_b32 v24, v21, v24
v_lshlrev_b32 v24, 4, v24
v_add_u32 v24, v24, v23
v_add_u32 v2, 4096, v24
v_or_b32 v24, 0, v22
v_xor_b32 v24, v21, v24
v_lshlrev_b32 v24, 4, v24
v_add_u32 v24, v24, v23
v_add_u32 v3, 3200, v24
v_or_b32 v24, 4, v22
v_xor_b32 v24, v21, v24
v_lshlrev_b32 v24, 4, v24
v_add_u32 v24, v24, v23
v_add_u32 v4, 18432, v24
v_or_b32 v24, 4, v22
v_xor_b32 v24, v21, v24
v_lshlrev_b32 v24, 4, v24
v_add_u32 v24, v24, v23
v_add_u32 v5, 17536, v24
s_waitcnt lgkmcnt(0)
s_mov_b32 s8, s16
s_mov_b32 s9, s17
s_mov_b32 s10, 32112640
s_mov_b32 s11, 0x00020000
s_mov_b32 s20, s54
s_mov_b32 s21, s55
s_mov_b32 s22, 2048
s_mov_b32 s23, 0x00020000
s_mov_b32 s24, s58
s_mov_b32 s25, s59
s_mov_b32 s26, 4194304
s_mov_b32 s27, 0x00020000
s_sub_u32 s42, s6, 4096
s_subb_u32 s43, s7, 0
s_sub_u32 s12, s4, 4096
s_subb_u32 s13, s5, 0
s_mov_b32 s14, 2101248
s_mov_b32 s15, 0x00020000
s_mov_b32 s39, 1048576
s_mov_b32 s38, 163840
s_mul_i32 s50, s34, 1474560
s_mul_i32 s51, s28, 5120
s_add_u32 s50, s50, s51
s_add_u32 s38, s38, s50
s_add_u32 s47, s50, 860160
s_mov_b32 s64, s100
s_mov_b32 s65, s101
s_mov_b32 s66, 256
s_mov_b32 s67, 0x00020000
v_mov_b32 v30, 0
buffer_load_dword v31, v30, s[64:67], 0 offen sc1
s_add_u32 m0, s40, 16384
s_nop 0
buffer_load_dwordx4 v2, s[12:15], s39 offen offset:0 lds
buffer_load_dwordx4 v3, s[12:15], s39 offen offset:1024 lds
buffer_load_dwordx4 v4, s[12:15], s39 offen offset:2048 lds
buffer_load_dwordx4 v5, s[12:15], s39 offen offset:3072 lds
s_add_u32 s39, s39, 131072
s_add_u32 m0, s40, 49152
s_nop 0
buffer_load_dwordx4 v2, s[12:15], s39 offen offset:0 lds
buffer_load_dwordx4 v3, s[12:15], s39 offen offset:1024 lds
buffer_load_dwordx4 v4, s[12:15], s39 offen offset:2048 lds
buffer_load_dwordx4 v5, s[12:15], s39 offen offset:3072 lds
s_add_u32 s39, s39, 131072
v_lshrrev_b32 v20, 4, v0
v_lshlrev_b32 v20, 3, v20
s_lshl_b32 s50, s35, 8
s_lshl_b32 s51, s30, 7
s_add_u32 s50, s50, s51
buffer_load_dwordx2 v[224:225], v20, s[20:23], s50 offen offset:0
buffer_load_dwordx2 v[226:227], v20, s[20:23], s50 offen offset:32
buffer_load_dwordx2 v[228:229], v20, s[20:23], s50 offen offset:64
buffer_load_dwordx2 v[230:231], v20, s[20:23], s50 offen offset:96
v_and_b32 v20, 15, v0
v_lshrrev_b32 v21, 4, v0
v_lshrrev_b32 v22, 1, v21
v_lshlrev_b32 v22, 12, v22
v_and_b32 v23, 1, v21
v_lshlrev_b32 v24, 9, v23
v_add_u32 v22, v22, v24
v_lshlrev_b32 v24, 4, v20
v_add_u32 v22, v22, v24
s_lshl_b32 s50, s29, 11
v_add_u32 v6, s50, v22
v_lshrrev_b32 v24, 2, v0
v_and_b32 v24, 3, v24
v_and_b32 v25, 3, v0
v_lshrrev_b32 v26, 1, v25
v_and_b32 v27, 2, v24
v_lshlrev_b32 v28, 2, v23
v_or_b32 v27, v27, v28
v_lshlrev_b32 v28, 11, v21
v_lshlrev_b32 v29, 7, v24
v_add_u32 v28, v28, v29
v_and_b32 v29, 1, v25
v_lshlrev_b32 v29, 3, v29
v_add_u32 v28, v28, v29
s_lshl_b32 s50, s30, 10
s_add_u32 s50, s50, 16384
v_add_u32 v28, s50, v28
v_or_b32 v29, 0, v26
v_xor_b32 v29, v29, v27
v_lshlrev_b32 v29, 4, v29
v_add_u32 v9, v28, v29
v_or_b32 v29, 2, v26
v_xor_b32 v29, v29, v27
v_lshlrev_b32 v29, 4, v29
v_add_u32 v10, v28, v29
v_or_b32 v29, 4, v26
v_xor_b32 v29, v29, v27
v_lshlrev_b32 v29, 4, v29
v_add_u32 v11, v28, v29
v_or_b32 v29, 6, v26
v_xor_b32 v29, v29, v27
v_lshlrev_b32 v29, 4, v29
v_add_u32 v12, v28, v29
v_add_u32 v7, 65536, v6
v_add_u32 v13, 65536, v9
v_add_u32 v14, 65536, v10
v_add_u32 v15, 65536, v11
v_add_u32 v16, 65536, v12
v_mov_b64 v[32:33], 0
v_mov_b64 v[34:35], 0
v_mov_b64 v[36:37], 0
v_mov_b64 v[38:39], 0
v_mov_b64 v[40:41], 0
v_mov_b64 v[42:43], 0
v_mov_b64 v[44:45], 0
v_mov_b64 v[46:47], 0
v_mov_b64 v[48:49], 0
v_mov_b64 v[50:51], 0
v_mov_b64 v[52:53], 0
v_mov_b64 v[54:55], 0
v_mov_b64 v[56:57], 0
v_mov_b64 v[58:59], 0
v_mov_b64 v[60:61], 0
v_mov_b64 v[62:63], 0
v_mov_b64 v[64:65], 0
v_mov_b64 v[66:67], 0
v_mov_b64 v[68:69], 0
v_mov_b64 v[70:71], 0
v_mov_b64 v[72:73], 0
v_mov_b64 v[74:75], 0
v_mov_b64 v[76:77], 0
v_mov_b64 v[78:79], 0
v_mov_b64 v[80:81], 0
v_mov_b64 v[82:83], 0
v_mov_b64 v[84:85], 0
v_mov_b64 v[86:87], 0
v_mov_b64 v[88:89], 0
v_mov_b64 v[90:91], 0
v_mov_b64 v[92:93], 0
v_mov_b64 v[94:95], 0
s_lshr_b32 s50, s34, 1
s_lshl_b32 s50, s50, 7
s_add_u32 s46, s50, 23625728
s_waitcnt vmcnt(12)
s_barrier
s_cmp_lg_u32 s28, 0
s_cbranch_scc1 L_p3_nopub_final
v_readfirstlane_b32 s63, v31
s_nop 3
s_cmp_ge_u32 s63, 256
s_cbranch_scc1 L_p3_initok_final
v_mov_b32 v30, 0
s_mov_b32 s62, 0
L_poll_init_final:
buffer_load_dword v29, v30, s[64:67], 0 offen sc1
s_waitcnt vmcnt(0)
v_readfirstlane_b32 s63, v29
s_nop 3
s_cmp_ge_u32 s63, 256
s_cbranch_scc1 L_got_init_final
s_add_u32 s62, s62, 1
s_cmp_lt_u32 s62, 20000
s_cbranch_scc0 L_got_init_final
s_sleep 1
s_branch L_poll_init_final
L_got_init_final:
L_p3_initok_final:
s_lshl_b32 s50, s37, 7
s_add_u32 s50, s50, s41
v_mov_b32 v29, 1
v_mov_b32 v30, 0
s_mov_b64 exec, 1
buffer_atomic_add v29, v30, s[16:19], s50 offen sc1
s_mov_b64 exec, -1
v_mov_b32 v30, 0
s_mov_b32 s62, 0
L_poll_cnt_final:
buffer_load_dword v29, v30, s[16:19], s46 offen sc1
s_waitcnt vmcnt(0)
v_readfirstlane_b32 s63, v29
s_nop 3
s_cmp_ge_u32 s63, 14
s_cbranch_scc1 L_got_cnt_final
s_add_u32 s62, s62, 1
s_cmp_lt_u32 s62, 20000
s_cbranch_scc0 L_got_cnt_final
s_sleep 1
s_branch L_poll_cnt_final
L_got_cnt_final:
L_p3_nopub_final:
s_barrier
s_add_u32 m0, s40, 0
s_nop 0
buffer_load_dwordx4 v17, s[8:11], s38 offen offset:0 lds
buffer_load_dwordx4 v18, s[8:11], s38 offen offset:1024 lds
buffer_load_dwordx4 v19, s[8:11], s38 offen offset:2048 lds
buffer_load_dwordx4 v8, s[8:11], s38 offen offset:3072 lds
s_add_u32 s38, s38, 20480
s_add_u32 m0, s40, 32768
s_nop 0
buffer_load_dwordx4 v17, s[8:11], s38 offen offset:0 lds
buffer_load_dwordx4 v18, s[8:11], s38 offen offset:1024 lds
buffer_load_dwordx4 v19, s[8:11], s38 offen offset:2048 lds
buffer_load_dwordx4 v8, s[8:11], s38 offen offset:3072 lds
s_add_u32 s38, s38, 20480
s_add_u32 m0, s40, 65536
s_nop 0
buffer_load_dwordx4 v17, s[8:11], s38 offen offset:0 lds
buffer_load_dwordx4 v18, s[8:11], s38 offen offset:1024 lds
buffer_load_dwordx4 v19, s[8:11], s38 offen offset:2048 lds
buffer_load_dwordx4 v8, s[8:11], s38 offen offset:3072 lds
s_add_u32 s38, s38, 40960
s_add_u32 m0, s40, 81920
s_nop 0
buffer_load_dwordx4 v2, s[12:15], s39 offen offset:0 lds
buffer_load_dwordx4 v3, s[12:15], s39 offen offset:1024 lds
buffer_load_dwordx4 v4, s[12:15], s39 offen offset:2048 lds
buffer_load_dwordx4 v5, s[12:15], s39 offen offset:3072 lds
s_add_u32 m0, s40, 98304
s_nop 0
buffer_load_dwordx4 v17, s[8:11], s38 offen offset:0 lds
buffer_load_dwordx4 v18, s[8:11], s38 offen offset:1024 lds
buffer_load_dwordx4 v19, s[8:11], s38 offen offset:2048 lds
buffer_load_dwordx4 v8, s[8:11], s38 offen offset:3072 lds
s_waitcnt vmcnt(16)
s_barrier
ds_read_b64_tr_b16 a[32:33], v9 offset:0
ds_read_b128 a[0:3], v6 offset:0
ds_read_b64_tr_b16 a[34:35], v9 offset:512
ds_read_b64_tr_b16 a[36:37], v10 offset:0
ds_read_b128 a[4:7], v6 offset:256
ds_read_b64_tr_b16 a[38:39], v10 offset:512
ds_read_b64_tr_b16 a[40:41], v11 offset:0
ds_read_b128 a[8:11], v6 offset:1024
ds_read_b64_tr_b16 a[42:43], v11 offset:512
ds_read_b64_tr_b16 a[44:45], v12 offset:0
ds_read_b128 a[12:15], v6 offset:1280
ds_read_b64_tr_b16 a[46:47], v12 offset:512
s_mov_b32 s33, 0
s_lshr_b32 s50, s34, 1
s_lshl_b32 s50, s50, 7
s_add_u32 s46, s50, 23626752
v_mov_b32 v30, 0
s_lshl_b32 s44, s36, 16
s_lshl_b32 s50, s28, 14
s_add_u32 s44, s44, s50
s_add_u32 s44, s44, 23658496
s_lshl_b32 s45, s36, 7
s_add_u32 s45, s45, 23642112
s_lshl_b32 s50, s28, 2
s_add_u32 s45, s45, s50
s_waitcnt lgkmcnt(0)
L_p3_loop_final:
s_cmp_eq_u32 s33, 2
s_cbranch_scc1 L_p3_sw_final
L_p3_sw_ret_final:
v_mfma_f32_16x16x32_bf16 v[32:35], a[32:35], a[0:3], v[32:35]
ds_read_b64_tr_b16 a[48:49], v9 offset:8192
s_cmp_eq_u32 s33, 0
s_cselect_b32 s49, 2, 1
s_cmp_eq_u32 s33, 1
s_cselect_b32 s49, -4, s49
s_mul_i32 s49, s49, 131072
v_mfma_f32_16x16x32_bf16 v[36:39], a[32:35], a[4:7], v[36:39]
ds_read_b128 a[16:19], v6 offset:8192
s_add_u32 s39, s39, s49
s_add_u32 m0, s40, 114688
v_mfma_f32_16x16x32_bf16 v[40:43], a[32:35], a[8:11], v[40:43]
ds_read_b64_tr_b16 a[50:51], v9 offset:8704
v_mfma_f32_16x16x32_bf16 v[44:47], a[32:35], a[12:15], v[44:47]
ds_read_b64_tr_b16 a[52:53], v10 offset:8192
v_mfma_f32_16x16x32_bf16 v[48:51], a[36:39], a[0:3], v[48:51]
ds_read_b128 a[20:23], v6 offset:8448
buffer_load_dwordx4 v2, s[12:15], s39 offen offset:0 lds
v_mfma_f32_16x16x32_bf16 v[52:55], a[36:39], a[4:7], v[52:55]
ds_read_b64_tr_b16 a[54:55], v10 offset:8704
v_mfma_f32_16x16x32_bf16 v[56:59], a[36:39], a[8:11], v[56:59]
ds_read_b64_tr_b16 a[56:57], v11 offset:8192
v_mfma_f32_16x16x32_bf16 v[60:63], a[36:39], a[12:15], v[60:63]
ds_read_b128 a[24:27], v6 offset:9216
buffer_load_dwordx4 v3, s[12:15], s39 offen offset:1024 lds
v_mfma_f32_16x16x32_bf16 v[64:67], a[40:43], a[0:3], v[64:67]
ds_read_b64_tr_b16 a[58:59], v11 offset:8704
v_mfma_f32_16x16x32_bf16 v[68:71], a[40:43], a[4:7], v[68:71]
ds_read_b64_tr_b16 a[60:61], v12 offset:8192
v_mfma_f32_16x16x32_bf16 v[72:75], a[40:43], a[8:11], v[72:75]
ds_read_b128 a[28:31], v6 offset:9472
buffer_load_dwordx4 v4, s[12:15], s39 offen offset:2048 lds
v_mfma_f32_16x16x32_bf16 v[76:79], a[40:43], a[12:15], v[76:79]
ds_read_b64_tr_b16 a[62:63], v12 offset:8704
v_mfma_f32_16x16x32_bf16 v[80:83], a[44:47], a[0:3], v[80:83]
v_mfma_f32_16x16x32_bf16 v[84:87], a[44:47], a[4:7], v[84:87]
buffer_load_dwordx4 v5, s[12:15], s39 offen offset:3072 lds
v_mfma_f32_16x16x32_bf16 v[88:91], a[44:47], a[8:11], v[88:91]
v_mfma_f32_16x16x32_bf16 v[92:95], a[44:47], a[12:15], v[92:95]
s_waitcnt vmcnt(16) lgkmcnt(0)
s_barrier
v_mfma_f32_16x16x32_bf16 v[32:35], a[48:51], a[16:19], v[32:35]
ds_read_b64_tr_b16 a[32:33], v9 offset:32768
s_add_u32 s38, s38, 20480
s_cmp_eq_u32 s33, 1
s_cselect_b32 s38, s47, s38
s_add_u32 m0, s40, 0
v_mfma_f32_16x16x32_bf16 v[36:39], a[48:51], a[20:23], v[36:39]
ds_read_b128 a[0:3], v6 offset:32768
v_mfma_f32_16x16x32_bf16 v[40:43], a[48:51], a[24:27], v[40:43]
ds_read_b64_tr_b16 a[34:35], v9 offset:33280
v_mfma_f32_16x16x32_bf16 v[44:47], a[48:51], a[28:31], v[44:47]
ds_read_b64_tr_b16 a[36:37], v10 offset:32768
v_mfma_f32_16x16x32_bf16 v[48:51], a[52:55], a[16:19], v[48:51]
ds_read_b128 a[4:7], v6 offset:33024
buffer_load_dwordx4 v17, s[8:11], s38 offen offset:0 lds
v_mfma_f32_16x16x32_bf16 v[52:55], a[52:55], a[20:23], v[52:55]
ds_read_b64_tr_b16 a[38:39], v10 offset:33280
v_mfma_f32_16x16x32_bf16 v[56:59], a[52:55], a[24:27], v[56:59]
ds_read_b64_tr_b16 a[40:41], v11 offset:32768
v_mfma_f32_16x16x32_bf16 v[60:63], a[52:55], a[28:31], v[60:63]
ds_read_b128 a[8:11], v6 offset:33792
buffer_load_dwordx4 v18, s[8:11], s38 offen offset:1024 lds
v_mfma_f32_16x16x32_bf16 v[64:67], a[56:59], a[16:19], v[64:67]
ds_read_b64_tr_b16 a[42:43], v11 offset:33280
v_mfma_f32_16x16x32_bf16 v[68:71], a[56:59], a[20:23], v[68:71]
ds_read_b64_tr_b16 a[44:45], v12 offset:32768
v_mfma_f32_16x16x32_bf16 v[72:75], a[56:59], a[24:27], v[72:75]
ds_read_b128 a[12:15], v6 offset:34048
buffer_load_dwordx4 v19, s[8:11], s38 offen offset:2048 lds
v_mfma_f32_16x16x32_bf16 v[76:79], a[56:59], a[28:31], v[76:79]
ds_read_b64_tr_b16 a[46:47], v12 offset:33280
v_mfma_f32_16x16x32_bf16 v[80:83], a[60:63], a[16:19], v[80:83]
v_mfma_f32_16x16x32_bf16 v[84:87], a[60:63], a[20:23], v[84:87]
buffer_load_dwordx4 v8, s[8:11], s38 offen offset:3072 lds
v_mfma_f32_16x16x32_bf16 v[88:91], a[60:63], a[24:27], v[88:91]
v_mfma_f32_16x16x32_bf16 v[92:95], a[60:63], a[28:31], v[92:95]
s_waitcnt lgkmcnt(0)
v_mfma_f32_16x16x32_bf16 v[32:35], a[32:35], a[0:3], v[32:35]
ds_read_b64_tr_b16 a[48:49], v9 offset:40960
s_add_u32 s39, s39, 131072
s_cmp_eq_u32 s33, 1
s_cselect_b32 s12, s42, s12
s_cselect_b32 s13, s43, s13
s_cselect_b32 s39, 3407872, s39
v_mfma_f32_16x16x32_bf16 v[36:39], a[32:35], a[4:7], v[36:39]
ds_read_b128 a[16:19], v6 offset:40960
s_cselect_b32 s14, 7344128, s14
s_add_u32 m0, s40, 16384
v_mfma_f32_16x16x32_bf16 v[40:43], a[32:35], a[8:11], v[40:43]
ds_read_b64_tr_b16 a[50:51], v9 offset:41472
v_mfma_f32_16x16x32_bf16 v[44:47], a[32:35], a[12:15], v[44:47]
ds_read_b64_tr_b16 a[52:53], v10 offset:40960
v_mfma_f32_16x16x32_bf16 v[48:51], a[36:39], a[0:3], v[48:51]
ds_read_b128 a[20:23], v6 offset:41216
buffer_load_dwordx4 v2, s[12:15], s39 offen offset:0 lds
v_mfma_f32_16x16x32_bf16 v[52:55], a[36:39], a[4:7], v[52:55]
ds_read_b64_tr_b16 a[54:55], v10 offset:41472
v_mfma_f32_16x16x32_bf16 v[56:59], a[36:39], a[8:11], v[56:59]
ds_read_b64_tr_b16 a[56:57], v11 offset:40960
v_mfma_f32_16x16x32_bf16 v[60:63], a[36:39], a[12:15], v[60:63]
ds_read_b128 a[24:27], v6 offset:41984
buffer_load_dwordx4 v3, s[12:15], s39 offen offset:1024 lds
v_mfma_f32_16x16x32_bf16 v[64:67], a[40:43], a[0:3], v[64:67]
ds_read_b64_tr_b16 a[58:59], v11 offset:41472
v_mfma_f32_16x16x32_bf16 v[68:71], a[40:43], a[4:7], v[68:71]
ds_read_b64_tr_b16 a[60:61], v12 offset:40960
v_mfma_f32_16x16x32_bf16 v[72:75], a[40:43], a[8:11], v[72:75]
ds_read_b128 a[28:31], v6 offset:42240
buffer_load_dwordx4 v4, s[12:15], s39 offen offset:2048 lds
v_mfma_f32_16x16x32_bf16 v[76:79], a[40:43], a[12:15], v[76:79]
ds_read_b64_tr_b16 a[62:63], v12 offset:41472
v_mfma_f32_16x16x32_bf16 v[80:83], a[44:47], a[0:3], v[80:83]
v_mfma_f32_16x16x32_bf16 v[84:87], a[44:47], a[4:7], v[84:87]
buffer_load_dwordx4 v5, s[12:15], s39 offen offset:3072 lds
v_mfma_f32_16x16x32_bf16 v[88:91], a[44:47], a[8:11], v[88:91]
v_mfma_f32_16x16x32_bf16 v[92:95], a[44:47], a[12:15], v[92:95]
s_waitcnt vmcnt(16) lgkmcnt(0)
s_barrier
v_mfma_f32_16x16x32_bf16 v[32:35], a[48:51], a[16:19], v[32:35]
ds_read_b64_tr_b16 a[32:33], v13 offset:0
s_add_u32 s38, s38, 20480
s_add_u32 m0, s40, 32768
v_mfma_f32_16x16x32_bf16 v[36:39], a[48:51], a[20:23], v[36:39]
ds_read_b128 a[0:3], v7 offset:0
v_mfma_f32_16x16x32_bf16 v[40:43], a[48:51], a[24:27], v[40:43]
ds_read_b64_tr_b16 a[34:35], v13 offset:512
v_mfma_f32_16x16x32_bf16 v[44:47], a[48:51], a[28:31], v[44:47]
ds_read_b64_tr_b16 a[36:37], v14 offset:0
v_mfma_f32_16x16x32_bf16 v[48:51], a[52:55], a[16:19], v[48:51]
ds_read_b128 a[4:7], v7 offset:256
buffer_load_dwordx4 v17, s[8:11], s38 offen offset:0 lds
v_mfma_f32_16x16x32_bf16 v[52:55], a[52:55], a[20:23], v[52:55]
ds_read_b64_tr_b16 a[38:39], v14 offset:512
v_mfma_f32_16x16x32_bf16 v[56:59], a[52:55], a[24:27], v[56:59]
ds_read_b64_tr_b16 a[40:41], v15 offset:0
v_mfma_f32_16x16x32_bf16 v[60:63], a[52:55], a[28:31], v[60:63]
ds_read_b128 a[8:11], v7 offset:1024
buffer_load_dwordx4 v18, s[8:11], s38 offen offset:1024 lds
v_mfma_f32_16x16x32_bf16 v[64:67], a[56:59], a[16:19], v[64:67]
ds_read_b64_tr_b16 a[42:43], v15 offset:512
v_mfma_f32_16x16x32_bf16 v[68:71], a[56:59], a[20:23], v[68:71]
ds_read_b64_tr_b16 a[44:45], v16 offset:0
v_mfma_f32_16x16x32_bf16 v[72:75], a[56:59], a[24:27], v[72:75]
ds_read_b128 a[12:15], v7 offset:1280
buffer_load_dwordx4 v19, s[8:11], s38 offen offset:2048 lds
v_mfma_f32_16x16x32_bf16 v[76:79], a[56:59], a[28:31], v[76:79]
ds_read_b64_tr_b16 a[46:47], v16 offset:512
v_mfma_f32_16x16x32_bf16 v[80:83], a[60:63], a[16:19], v[80:83]
v_mfma_f32_16x16x32_bf16 v[84:87], a[60:63], a[20:23], v[84:87]
buffer_load_dwordx4 v8, s[8:11], s38 offen offset:3072 lds
v_mfma_f32_16x16x32_bf16 v[88:91], a[60:63], a[24:27], v[88:91]
v_mfma_f32_16x16x32_bf16 v[92:95], a[60:63], a[28:31], v[92:95]
s_waitcnt lgkmcnt(0)
v_mfma_f32_16x16x32_bf16 v[32:35], a[32:35], a[0:3], v[32:35]
ds_read_b64_tr_b16 a[48:49], v13 offset:8192
s_add_u32 s39, s39, 131072
s_add_u32 m0, s40, 49152
v_mfma_f32_16x16x32_bf16 v[36:39], a[32:35], a[4:7], v[36:39]
ds_read_b128 a[16:19], v7 offset:8192
v_mfma_f32_16x16x32_bf16 v[40:43], a[32:35], a[8:11], v[40:43]
ds_read_b64_tr_b16 a[50:51], v13 offset:8704
v_mfma_f32_16x16x32_bf16 v[44:47], a[32:35], a[12:15], v[44:47]
ds_read_b64_tr_b16 a[52:53], v14 offset:8192
v_mfma_f32_16x16x32_bf16 v[48:51], a[36:39], a[0:3], v[48:51]
ds_read_b128 a[20:23], v7 offset:8448
buffer_load_dwordx4 v2, s[12:15], s39 offen offset:0 lds
v_mfma_f32_16x16x32_bf16 v[52:55], a[36:39], a[4:7], v[52:55]
ds_read_b64_tr_b16 a[54:55], v14 offset:8704
v_mfma_f32_16x16x32_bf16 v[56:59], a[36:39], a[8:11], v[56:59]
ds_read_b64_tr_b16 a[56:57], v15 offset:8192
v_mfma_f32_16x16x32_bf16 v[60:63], a[36:39], a[12:15], v[60:63]
ds_read_b128 a[24:27], v7 offset:9216
buffer_load_dwordx4 v3, s[12:15], s39 offen offset:1024 lds
v_mfma_f32_16x16x32_bf16 v[64:67], a[40:43], a[0:3], v[64:67]
ds_read_b64_tr_b16 a[58:59], v15 offset:8704
v_mfma_f32_16x16x32_bf16 v[68:71], a[40:43], a[4:7], v[68:71]
ds_read_b64_tr_b16 a[60:61], v16 offset:8192
v_mfma_f32_16x16x32_bf16 v[72:75], a[40:43], a[8:11], v[72:75]
ds_read_b128 a[28:31], v7 offset:9472
buffer_load_dwordx4 v4, s[12:15], s39 offen offset:2048 lds
v_mfma_f32_16x16x32_bf16 v[76:79], a[40:43], a[12:15], v[76:79]
ds_read_b64_tr_b16 a[62:63], v16 offset:8704
v_mfma_f32_16x16x32_bf16 v[80:83], a[44:47], a[0:3], v[80:83]
v_mfma_f32_16x16x32_bf16 v[84:87], a[44:47], a[4:7], v[84:87]
buffer_load_dwordx4 v5, s[12:15], s39 offen offset:3072 lds
v_mfma_f32_16x16x32_bf16 v[88:91], a[44:47], a[8:11], v[88:91]
v_mfma_f32_16x16x32_bf16 v[92:95], a[44:47], a[12:15], v[92:95]
s_cmp_eq_u32 s33, 0
s_cbranch_scc0 L_p3_nopf_final
buffer_load_dword v29, v30, s[16:19], s46 offen sc1
L_p3_nopf_final:
s_waitcnt vmcnt(16) lgkmcnt(0)
s_barrier
v_mfma_f32_16x16x32_bf16 v[32:35], a[48:51], a[16:19], v[32:35]
ds_read_b64_tr_b16 a[32:33], v13 offset:32768
s_add_u32 s38, s38, 20480
s_cmp_eq_u32 s33, 8
s_cselect_b32 s10, 0, s10
s_add_u32 m0, s40, 65536
v_mfma_f32_16x16x32_bf16 v[36:39], a[48:51], a[20:23], v[36:39]
ds_read_b128 a[0:3], v7 offset:32768
v_mfma_f32_16x16x32_bf16 v[40:43], a[48:51], a[24:27], v[40:43]
ds_read_b64_tr_b16 a[34:35], v13 offset:33280
v_mfma_f32_16x16x32_bf16 v[44:47], a[48:51], a[28:31], v[44:47]
ds_read_b64_tr_b16 a[36:37], v14 offset:32768
v_mfma_f32_16x16x32_bf16 v[48:51], a[52:55], a[16:19], v[48:51]
ds_read_b128 a[4:7], v7 offset:33024
buffer_load_dwordx4 v17, s[8:11], s38 offen offset:0 lds
v_mfma_f32_16x16x32_bf16 v[52:55], a[52:55], a[20:23], v[52:55]
ds_read_b64_tr_b16 a[38:39], v14 offset:33280
v_mfma_f32_16x16x32_bf16 v[56:59], a[52:55], a[24:27], v[56:59]
ds_read_b64_tr_b16 a[40:41], v15 offset:32768
v_mfma_f32_16x16x32_bf16 v[60:63], a[52:55], a[28:31], v[60:63]
ds_read_b128 a[8:11], v7 offset:33792
buffer_load_dwordx4 v18, s[8:11], s38 offen offset:1024 lds
v_mfma_f32_16x16x32_bf16 v[64:67], a[56:59], a[16:19], v[64:67]
ds_read_b64_tr_b16 a[42:43], v15 offset:33280
v_mfma_f32_16x16x32_bf16 v[68:71], a[56:59], a[20:23], v[68:71]
ds_read_b64_tr_b16 a[44:45], v16 offset:32768
v_mfma_f32_16x16x32_bf16 v[72:75], a[56:59], a[24:27], v[72:75]
ds_read_b128 a[12:15], v7 offset:34048
buffer_load_dwordx4 v19, s[8:11], s38 offen offset:2048 lds
v_mfma_f32_16x16x32_bf16 v[76:79], a[56:59], a[28:31], v[76:79]
ds_read_b64_tr_b16 a[46:47], v16 offset:33280
v_mfma_f32_16x16x32_bf16 v[80:83], a[60:63], a[16:19], v[80:83]
v_mfma_f32_16x16x32_bf16 v[84:87], a[60:63], a[20:23], v[84:87]
buffer_load_dwordx4 v8, s[8:11], s38 offen offset:3072 lds
v_mfma_f32_16x16x32_bf16 v[88:91], a[60:63], a[24:27], v[88:91]
v_mfma_f32_16x16x32_bf16 v[92:95], a[60:63], a[28:31], v[92:95]
s_waitcnt lgkmcnt(0)
v_mfma_f32_16x16x32_bf16 v[32:35], a[32:35], a[0:3], v[32:35]
ds_read_b64_tr_b16 a[48:49], v13 offset:40960
s_add_u32 s39, s39, 131072
s_cmp_eq_u32 s33, 8
s_cselect_b32 s14, 0, s14
s_add_u32 m0, s40, 81920
v_mfma_f32_16x16x32_bf16 v[36:39], a[32:35], a[4:7], v[36:39]
ds_read_b128 a[16:19], v7 offset:40960
v_mfma_f32_16x16x32_bf16 v[40:43], a[32:35], a[8:11], v[40:43]
ds_read_b64_tr_b16 a[50:51], v13 offset:41472
v_mfma_f32_16x16x32_bf16 v[44:47], a[32:35], a[12:15], v[44:47]
ds_read_b64_tr_b16 a[52:53], v14 offset:40960
v_mfma_f32_16x16x32_bf16 v[48:51], a[36:39], a[0:3], v[48:51]
ds_read_b128 a[20:23], v7 offset:41216
buffer_load_dwordx4 v2, s[12:15], s39 offen offset:0 lds
v_mfma_f32_16x16x32_bf16 v[52:55], a[36:39], a[4:7], v[52:55]
ds_read_b64_tr_b16 a[54:55], v14 offset:41472
v_mfma_f32_16x16x32_bf16 v[56:59], a[36:39], a[8:11], v[56:59]
ds_read_b64_tr_b16 a[56:57], v15 offset:40960
v_mfma_f32_16x16x32_bf16 v[60:63], a[36:39], a[12:15], v[60:63]
ds_read_b128 a[24:27], v7 offset:41984
buffer_load_dwordx4 v3, s[12:15], s39 offen offset:1024 lds
v_mfma_f32_16x16x32_bf16 v[64:67], a[40:43], a[0:3], v[64:67]
ds_read_b64_tr_b16 a[58:59], v15 offset:41472
v_mfma_f32_16x16x32_bf16 v[68:71], a[40:43], a[4:7], v[68:71]
ds_read_b64_tr_b16 a[60:61], v16 offset:40960
v_mfma_f32_16x16x32_bf16 v[72:75], a[40:43], a[8:11], v[72:75]
ds_read_b128 a[28:31], v7 offset:42240
buffer_load_dwordx4 v4, s[12:15], s39 offen offset:2048 lds
v_mfma_f32_16x16x32_bf16 v[76:79], a[40:43], a[12:15], v[76:79]
ds_read_b64_tr_b16 a[62:63], v16 offset:41472
v_mfma_f32_16x16x32_bf16 v[80:83], a[44:47], a[0:3], v[80:83]
v_mfma_f32_16x16x32_bf16 v[84:87], a[44:47], a[4:7], v[84:87]
buffer_load_dwordx4 v5, s[12:15], s39 offen offset:3072 lds
v_mfma_f32_16x16x32_bf16 v[88:91], a[44:47], a[8:11], v[88:91]
v_mfma_f32_16x16x32_bf16 v[92:95], a[44:47], a[12:15], v[92:95]
s_waitcnt vmcnt(16) lgkmcnt(0)
s_barrier
s_cmp_eq_u32 s33, 0
s_cbranch_scc1 L_p3_chk_final
L_p3_chk_ret_final:
v_mfma_f32_16x16x32_bf16 v[32:35], a[48:51], a[16:19], v[32:35]
ds_read_b64_tr_b16 a[32:33], v9 offset:0
s_cmp_eq_u32 s33, 0
s_cselect_b32 s49, -4, 1
s_mul_i32 s49, s49, 20480
s_add_u32 s38, s38, s49
s_add_u32 m0, s40, 98304
v_mfma_f32_16x16x32_bf16 v[36:39], a[48:51], a[20:23], v[36:39]
ds_read_b128 a[0:3], v6 offset:0
v_mfma_f32_16x16x32_bf16 v[40:43], a[48:51], a[24:27], v[40:43]
ds_read_b64_tr_b16 a[34:35], v9 offset:512
v_mfma_f32_16x16x32_bf16 v[44:47], a[48:51], a[28:31], v[44:47]
ds_read_b64_tr_b16 a[36:37], v10 offset:0
v_mfma_f32_16x16x32_bf16 v[48:51], a[52:55], a[16:19], v[48:51]
ds_read_b128 a[4:7], v6 offset:256
buffer_load_dwordx4 v17, s[8:11], s38 offen offset:0 lds
v_mfma_f32_16x16x32_bf16 v[52:55], a[52:55], a[20:23], v[52:55]
ds_read_b64_tr_b16 a[38:39], v10 offset:512
v_mfma_f32_16x16x32_bf16 v[56:59], a[52:55], a[24:27], v[56:59]
ds_read_b64_tr_b16 a[40:41], v11 offset:0
v_mfma_f32_16x16x32_bf16 v[60:63], a[52:55], a[28:31], v[60:63]
ds_read_b128 a[8:11], v6 offset:1024
buffer_load_dwordx4 v18, s[8:11], s38 offen offset:1024 lds
v_mfma_f32_16x16x32_bf16 v[64:67], a[56:59], a[16:19], v[64:67]
ds_read_b64_tr_b16 a[42:43], v11 offset:512
v_mfma_f32_16x16x32_bf16 v[68:71], a[56:59], a[20:23], v[68:71]
ds_read_b64_tr_b16 a[44:45], v12 offset:0
v_mfma_f32_16x16x32_bf16 v[72:75], a[56:59], a[24:27], v[72:75]
ds_read_b128 a[12:15], v6 offset:1280
buffer_load_dwordx4 v19, s[8:11], s38 offen offset:2048 lds
v_mfma_f32_16x16x32_bf16 v[76:79], a[56:59], a[28:31], v[76:79]
ds_read_b64_tr_b16 a[46:47], v12 offset:512
v_mfma_f32_16x16x32_bf16 v[80:83], a[60:63], a[16:19], v[80:83]
v_mfma_f32_16x16x32_bf16 v[84:87], a[60:63], a[20:23], v[84:87]
buffer_load_dwordx4 v8, s[8:11], s38 offen offset:3072 lds
v_mfma_f32_16x16x32_bf16 v[88:91], a[60:63], a[24:27], v[88:91]
v_mfma_f32_16x16x32_bf16 v[92:95], a[60:63], a[28:31], v[92:95]
s_waitcnt lgkmcnt(0)
s_cmp_eq_u32 s33, 8
s_cbranch_scc1 L_p3_tail_final
s_add_u32 s33, s33, 1
s_branch L_p3_loop_final
L_p3_sw_final:
s_nop 7
v_sub_f32 v25, 1.0, v21
v_cvt_pk_bf16_f32 v25, v25, v25
v_lshlrev_b32 v25, 16, v25
v_sub_f32 v26, 1.0, v22
v_cvt_pk_bf16_f32 v26, v26, v26
v_lshlrev_b32 v26, 16, v26
v_sub_f32 v27, 1.0, v23
v_cvt_pk_bf16_f32 v27, v27, v27
v_lshlrev_b32 v27, 16, v27
v_sub_f32 v28, 1.0, v24
v_cvt_pk_bf16_f32 v28, v28, v28
v_lshlrev_b32 v28, 16, v28
v_pk_mul_f32 v[96:97], v[32:33], v[20:21] op_sel:[0,1] op_sel_hi:[1,1]
v_pk_mul_f32 v[98:99], v[34:35], v[20:21] op_sel:[0,1] op_sel_hi:[1,1]
v_pk_mul_f32 v[100:101], v[36:37], v[22:23] op_sel:[0,0] op_sel_hi:[1,0]
v_pk_mul_f32 v[102:103], v[38:39], v[22:23] op_sel:[0,0] op_sel_hi:[1,0]
v_pk_mul_f32 v[104:105], v[40:41], v[22:23] op_sel:[0,1] op_sel_hi:[1,1]
v_pk_mul_f32 v[106:107], v[42:43], v[22:23] op_sel:[0,1] op_sel_hi:[1,1]
v_pk_mul_f32 v[108:109], v[44:45], v[24:25] op_sel:[0,0] op_sel_hi:[1,0]
v_pk_mul_f32 v[110:111], v[46:47], v[24:25] op_sel:[0,0] op_sel_hi:[1,0]
v_pk_mul_f32 v[112:113], v[48:49], v[20:21] op_sel:[0,1] op_sel_hi:[1,1]
v_pk_mul_f32 v[114:115], v[50:51], v[20:21] op_sel:[0,1] op_sel_hi:[1,1]
v_pk_mul_f32 v[116:117], v[52:53], v[22:23] op_sel:[0,0] op_sel_hi:[1,0]
v_pk_mul_f32 v[118:119], v[54:55], v[22:23] op_sel:[0,0] op_sel_hi:[1,0]
v_pk_mul_f32 v[120:121], v[56:57], v[22:23] op_sel:[0,1] op_sel_hi:[1,1]
v_pk_mul_f32 v[122:123], v[58:59], v[22:23] op_sel:[0,1] op_sel_hi:[1,1]
v_pk_mul_f32 v[124:125], v[60:61], v[24:25] op_sel:[0,0] op_sel_hi:[1,0]
v_pk_mul_f32 v[126:127], v[62:63], v[24:25] op_sel:[0,0] op_sel_hi:[1,0]
v_pk_mul_f32 v[128:129], v[64:65], v[20:21] op_sel:[0,1] op_sel_hi:[1,1]
v_pk_mul_f32 v[130:131], v[66:67], v[20:21] op_sel:[0,1] op_sel_hi:[1,1]
v_pk_mul_f32 v[132:133], v[68:69], v[22:23] op_sel:[0,0] op_sel_hi:[1,0]
v_pk_mul_f32 v[134:135], v[70:71], v[22:23] op_sel:[0,0] op_sel_hi:[1,0]
v_pk_mul_f32 v[136:137], v[72:73], v[22:23] op_sel:[0,1] op_sel_hi:[1,1]
v_pk_mul_f32 v[138:139], v[74:75], v[22:23] op_sel:[0,1] op_sel_hi:[1,1]
v_pk_mul_f32 v[140:141], v[76:77], v[24:25] op_sel:[0,0] op_sel_hi:[1,0]
v_pk_mul_f32 v[142:143], v[78:79], v[24:25] op_sel:[0,0] op_sel_hi:[1,0]
v_pk_mul_f32 v[144:145], v[80:81], v[20:21] op_sel:[0,1] op_sel_hi:[1,1]
v_pk_mul_f32 v[146:147], v[82:83], v[20:21] op_sel:[0,1] op_sel_hi:[1,1]
v_pk_mul_f32 v[148:149], v[84:85], v[22:23] op_sel:[0,0] op_sel_hi:[1,0]
v_pk_mul_f32 v[150:151], v[86:87], v[22:23] op_sel:[0,0] op_sel_hi:[1,0]
v_pk_mul_f32 v[152:153], v[88:89], v[22:23] op_sel:[0,1] op_sel_hi:[1,1]
v_pk_mul_f32 v[154:155], v[90:91], v[22:23] op_sel:[0,1] op_sel_hi:[1,1]
v_pk_mul_f32 v[156:157], v[92:93], v[24:25] op_sel:[0,0] op_sel_hi:[1,0]
v_pk_mul_f32 v[158:159], v[94:95], v[24:25] op_sel:[0,0] op_sel_hi:[1,0]
v_lshlrev_b32 v44, 16, v224
v_and_b32 v45, 0xffff0000, v224
v_lshlrev_b32 v46, 16, v225
v_and_b32 v47, 0xffff0000, v225
v_mov_b64 v[32:33], v[44:45]
v_mov_b64 v[34:35], v[46:47]
v_mov_b64 v[36:37], v[44:45]
v_mov_b64 v[38:39], v[46:47]
v_mov_b64 v[40:41], v[44:45]
v_mov_b64 v[42:43], v[46:47]
v_lshlrev_b32 v60, 16, v226
v_and_b32 v61, 0xffff0000, v226
v_lshlrev_b32 v62, 16, v227
v_and_b32 v63, 0xffff0000, v227
v_mov_b64 v[48:49], v[60:61]
v_mov_b64 v[50:51], v[62:63]
v_mov_b64 v[52:53], v[60:61]
v_mov_b64 v[54:55], v[62:63]
v_mov_b64 v[56:57], v[60:61]
v_mov_b64 v[58:59], v[62:63]
v_lshlrev_b32 v76, 16, v228
v_and_b32 v77, 0xffff0000, v228
v_lshlrev_b32 v78, 16, v229
v_and_b32 v79, 0xffff0000, v229
v_mov_b64 v[64:65], v[76:77]
v_mov_b64 v[66:67], v[78:79]
v_mov_b64 v[68:69], v[76:77]
v_mov_b64 v[70:71], v[78:79]
v_mov_b64 v[72:73], v[76:77]
v_mov_b64 v[74:75], v[78:79]
v_lshlrev_b32 v92, 16, v230
v_and_b32 v93, 0xffff0000, v230
v_lshlrev_b32 v94, 16, v231
v_and_b32 v95, 0xffff0000, v231
v_mov_b64 v[80:81], v[92:93]
v_mov_b64 v[82:83], v[94:95]
v_mov_b64 v[84:85], v[92:93]
v_mov_b64 v[86:87], v[94:95]
v_mov_b64 v[88:89], v[92:93]
v_mov_b64 v[90:91], v[94:95]
s_nop 1
s_branch L_p3_sw_ret_final
L_p3_chk_final:
s_waitcnt vmcnt(8)
v_readfirstlane_b32 s63, v29
s_nop 3
s_cmp_ge_u32 s63, 18
s_cbranch_scc1 L_p3_chk_ok_final
v_mov_b32 v30, 0
s_mov_b32 s62, 0
L_poll_late_final:
buffer_load_dword v29, v30, s[16:19], s46 offen sc1
s_waitcnt vmcnt(0)
v_readfirstlane_b32 s63, v29
s_nop 3
s_cmp_ge_u32 s63, 18
s_cbranch_scc1 L_got_late_final
s_add_u32 s62, s62, 1
s_cmp_lt_u32 s62, 20000
s_cbranch_scc0 L_got_late_final
s_sleep 1
s_branch L_poll_late_final
L_got_late_final:
L_p3_chk_ok_final:
v_and_b32 v29, 15, v0
v_lshrrev_b32 v30, 3, v29
v_lshlrev_b32 v30, 7, v30
v_and_b32 v29, 7, v29
v_lshlrev_b32 v29, 3, v29
v_add_u32 v29, v29, v30
s_lshl_b32 s50, s34, 10
s_lshl_b32 s51, s29, 9
s_add_u32 s50, s50, s51
s_add_u32 s50, s50, 23592960
buffer_load_dword v21, v29, s[16:19], s50 offen offset:0 sc1
buffer_load_dword v22, v29, s[16:19], s50 offen offset:4 sc1
buffer_load_dword v23, v29, s[16:19], s50 offen offset:256 sc1
buffer_load_dword v24, v29, s[16:19], s50 offen offset:260 sc1
v_mov_b32 v30, 0
s_branch L_p3_chk_ret_final
L_p3_tail_final:
v_mfma_f32_16x16x32_bf16 v[32:35], a[32:35], a[0:3], v[32:35]
ds_read_b64_tr_b16 a[48:49], v9 offset:8192
v_mfma_f32_16x16x32_bf16 v[36:39], a[32:35], a[4:7], v[36:39]
ds_read_b128 a[16:19], v6 offset:8192
v_mfma_f32_16x16x32_bf16 v[40:43], a[32:35], a[8:11], v[40:43]
ds_read_b64_tr_b16 a[50:51], v9 offset:8704
v_mfma_f32_16x16x32_bf16 v[44:47], a[32:35], a[12:15], v[44:47]
ds_read_b64_tr_b16 a[52:53], v10 offset:8192
v_mfma_f32_16x16x32_bf16 v[48:51], a[36:39], a[0:3], v[48:51]
ds_read_b128 a[20:23], v6 offset:8448
v_mfma_f32_16x16x32_bf16 v[52:55], a[36:39], a[4:7], v[52:55]
ds_read_b64_tr_b16 a[54:55], v10 offset:8704
v_mfma_f32_16x16x32_bf16 v[56:59], a[36:39], a[8:11], v[56:59]
ds_read_b64_tr_b16 a[56:57], v11 offset:8192
v_mfma_f32_16x16x32_bf16 v[60:63], a[36:39], a[12:15], v[60:63]
ds_read_b128 a[24:27], v6 offset:9216
v_mfma_f32_16x16x32_bf16 v[64:67], a[40:43], a[0:3], v[64:67]
ds_read_b64_tr_b16 a[58:59], v11 offset:8704
v_mfma_f32_16x16x32_bf16 v[68:71], a[40:43], a[4:7], v[68:71]
ds_read_b64_tr_b16 a[60:61], v12 offset:8192
v_mfma_f32_16x16x32_bf16 v[72:75], a[40:43], a[8:11], v[72:75]
ds_read_b128 a[28:31], v6 offset:9472
v_mfma_f32_16x16x32_bf16 v[76:79], a[40:43], a[12:15], v[76:79]
ds_read_b64_tr_b16 a[62:63], v12 offset:8704
v_mfma_f32_16x16x32_bf16 v[80:83], a[44:47], a[0:3], v[80:83]
v_mfma_f32_16x16x32_bf16 v[84:87], a[44:47], a[4:7], v[84:87]
v_mfma_f32_16x16x32_bf16 v[88:91], a[44:47], a[8:11], v[88:91]
v_mfma_f32_16x16x32_bf16 v[92:95], a[44:47], a[12:15], v[92:95]
s_waitcnt vmcnt(0) lgkmcnt(0)
s_barrier
buffer_load_dword v29, v30, s[16:19], s45 offen sc1
v_mfma_f32_16x16x32_bf16 v[32:35], a[48:51], a[16:19], v[32:35]
ds_read_b64_tr_b16 a[32:33], v9 offset:32768
v_mfma_f32_16x16x32_bf16 v[36:39], a[48:51], a[20:23], v[36:39]
ds_read_b128 a[0:3], v6 offset:32768
v_mfma_f32_16x16x32_bf16 v[40:43], a[48:51], a[24:27], v[40:43]
ds_read_b64_tr_b16 a[34:35], v9 offset:33280
v_mfma_f32_16x16x32_bf16 v[44:47], a[48:51], a[28:31], v[44:47]
ds_read_b64_tr_b16 a[36:37], v10 offset:32768
v_mfma_f32_16x16x32_bf16 v[48:51], a[52:55], a[16:19], v[48:51]
ds_read_b128 a[4:7], v6 offset:33024
v_mfma_f32_16x16x32_bf16 v[52:55], a[52:55], a[20:23], v[52:55]
ds_read_b64_tr_b16 a[38:39], v10 offset:33280
v_mfma_f32_16x16x32_bf16 v[56:59], a[52:55], a[24:27], v[56:59]
ds_read_b64_tr_b16 a[40:41], v11 offset:32768
v_mfma_f32_16x16x32_bf16 v[60:63], a[52:55], a[28:31], v[60:63]
ds_read_b128 a[8:11], v6 offset:33792
v_mfma_f32_16x16x32_bf16 v[64:67], a[56:59], a[16:19], v[64:67]
ds_read_b64_tr_b16 a[42:43], v11 offset:33280
v_mfma_f32_16x16x32_bf16 v[68:71], a[56:59], a[20:23], v[68:71]
ds_read_b64_tr_b16 a[44:45], v12 offset:32768
v_mfma_f32_16x16x32_bf16 v[72:75], a[56:59], a[24:27], v[72:75]
ds_read_b128 a[12:15], v6 offset:34048
v_mfma_f32_16x16x32_bf16 v[76:79], a[56:59], a[28:31], v[76:79]
ds_read_b64_tr_b16 a[46:47], v12 offset:33280
v_mfma_f32_16x16x32_bf16 v[80:83], a[60:63], a[16:19], v[80:83]
v_mfma_f32_16x16x32_bf16 v[84:87], a[60:63], a[20:23], v[84:87]
v_mfma_f32_16x16x32_bf16 v[88:91], a[60:63], a[24:27], v[88:91]
v_mfma_f32_16x16x32_bf16 v[92:95], a[60:63], a[28:31], v[92:95]
s_waitcnt vmcnt(0) lgkmcnt(0)
v_readfirstlane_b32 s48, v29
s_nop 3
s_cmp_ge_u32 s48, 1
s_cbranch_scc0 L_p3_nop1
s_add_u32 s50, s44, 0
buffer_load_dwordx4 v[160:163], v1, s[16:19], s50 offen offset:0 sc1
buffer_load_dwordx4 v[164:167], v1, s[16:19], s50 offen offset:1024 sc1
buffer_load_dwordx4 v[168:171], v1, s[16:19], s50 offen offset:2048 sc1
buffer_load_dwordx4 v[172:175], v1, s[16:19], s50 offen offset:3072 sc1
s_add_u32 s50, s44, 4096
buffer_load_dwordx4 v[176:179], v1, s[16:19], s50 offen offset:0 sc1
buffer_load_dwordx4 v[180:183], v1, s[16:19], s50 offen offset:1024 sc1
buffer_load_dwordx4 v[184:187], v1, s[16:19], s50 offen offset:2048 sc1
buffer_load_dwordx4 v[188:191], v1, s[16:19], s50 offen offset:3072 sc1
s_branch L_p3_p1done
L_p3_nop1:
buffer_load_dword v29, v30, s[16:19], s45 offen sc1
L_p3_p1done:
v_mfma_f32_16x16x32_bf16 v[32:35], a[32:35], a[0:3], v[32:35]
ds_read_b64_tr_b16 a[48:49], v9 offset:40960
v_mfma_f32_16x16x32_bf16 v[36:39], a[32:35], a[4:7], v[36:39]
ds_read_b128 a[16:19], v6 offset:40960
v_mfma_f32_16x16x32_bf16 v[40:43], a[32:35], a[8:11], v[40:43]
ds_read_b64_tr_b16 a[50:51], v9 offset:41472
v_mfma_f32_16x16x32_bf16 v[44:47], a[32:35], a[12:15], v[44:47]
ds_read_b64_tr_b16 a[52:53], v10 offset:40960
v_mfma_f32_16x16x32_bf16 v[48:51], a[36:39], a[0:3], v[48:51]
ds_read_b128 a[20:23], v6 offset:41216
v_mfma_f32_16x16x32_bf16 v[52:55], a[36:39], a[4:7], v[52:55]
ds_read_b64_tr_b16 a[54:55], v10 offset:41472
v_mfma_f32_16x16x32_bf16 v[56:59], a[36:39], a[8:11], v[56:59]
ds_read_b64_tr_b16 a[56:57], v11 offset:40960
v_mfma_f32_16x16x32_bf16 v[60:63], a[36:39], a[12:15], v[60:63]
ds_read_b128 a[24:27], v6 offset:41984
v_mfma_f32_16x16x32_bf16 v[64:67], a[40:43], a[0:3], v[64:67]
ds_read_b64_tr_b16 a[58:59], v11 offset:41472
v_mfma_f32_16x16x32_bf16 v[68:71], a[40:43], a[4:7], v[68:71]
ds_read_b64_tr_b16 a[60:61], v12 offset:40960
v_mfma_f32_16x16x32_bf16 v[72:75], a[40:43], a[8:11], v[72:75]
ds_read_b128 a[28:31], v6 offset:42240
v_mfma_f32_16x16x32_bf16 v[76:79], a[40:43], a[12:15], v[76:79]
ds_read_b64_tr_b16 a[62:63], v12 offset:41472
v_mfma_f32_16x16x32_bf16 v[80:83], a[44:47], a[0:3], v[80:83]
v_mfma_f32_16x16x32_bf16 v[84:87], a[44:47], a[4:7], v[84:87]
v_mfma_f32_16x16x32_bf16 v[88:91], a[44:47], a[8:11], v[88:91]
v_mfma_f32_16x16x32_bf16 v[92:95], a[44:47], a[12:15], v[92:95]
s_waitcnt lgkmcnt(0)
v_mfma_f32_16x16x32_bf16 v[32:35], a[48:51], a[16:19], v[32:35]
v_mfma_f32_16x16x32_bf16 v[36:39], a[48:51], a[20:23], v[36:39]
v_mfma_f32_16x16x32_bf16 v[40:43], a[48:51], a[24:27], v[40:43]
v_mfma_f32_16x16x32_bf16 v[44:47], a[48:51], a[28:31], v[44:47]
v_mfma_f32_16x16x32_bf16 v[48:51], a[52:55], a[16:19], v[48:51]
v_mfma_f32_16x16x32_bf16 v[52:55], a[52:55], a[20:23], v[52:55]
v_mfma_f32_16x16x32_bf16 v[56:59], a[52:55], a[24:27], v[56:59]
v_mfma_f32_16x16x32_bf16 v[60:63], a[52:55], a[28:31], v[60:63]
v_mfma_f32_16x16x32_bf16 v[64:67], a[56:59], a[16:19], v[64:67]
v_mfma_f32_16x16x32_bf16 v[68:71], a[56:59], a[20:23], v[68:71]
v_mfma_f32_16x16x32_bf16 v[72:75], a[56:59], a[24:27], v[72:75]
v_mfma_f32_16x16x32_bf16 v[76:79], a[56:59], a[28:31], v[76:79]
v_mfma_f32_16x16x32_bf16 v[80:83], a[60:63], a[16:19], v[80:83]
v_mfma_f32_16x16x32_bf16 v[84:87], a[60:63], a[20:23], v[84:87]
v_mfma_f32_16x16x32_bf16 v[88:91], a[60:63], a[24:27], v[88:91]
v_mfma_f32_16x16x32_bf16 v[92:95], a[60:63], a[28:31], v[92:95]
L_p3_done_final:
s_cmp_ge_u32 s48, 1
s_cbranch_scc1 L_p3_havep1
s_waitcnt vmcnt(0)
v_readfirstlane_b32 s63, v29
s_nop 3
s_cmp_ge_u32 s63, 1
s_cbranch_scc1 L_p3_seen2
v_mov_b32 v30, 0
s_mov_b32 s62, 0
L_poll_pair:
buffer_load_dword v29, v30, s[16:19], s45 offen sc1
s_waitcnt vmcnt(0)
v_readfirstlane_b32 s63, v29
s_nop 3
s_cmp_ge_u32 s63, 1
s_cbranch_scc1 L_got_pair
s_add_u32 s62, s62, 1
s_cmp_lt_u32 s62, 20000
s_cbranch_scc0 L_got_pair
s_sleep 1
s_branch L_poll_pair
L_got_pair:
L_p3_seen2:
s_add_u32 s50, s44, 0
buffer_load_dwordx4 v[160:163], v1, s[16:19], s50 offen offset:0 sc1
buffer_load_dwordx4 v[164:167], v1, s[16:19], s50 offen offset:1024 sc1
buffer_load_dwordx4 v[168:171], v1, s[16:19], s50 offen offset:2048 sc1
buffer_load_dwordx4 v[172:175], v1, s[16:19], s50 offen offset:3072 sc1
s_add_u32 s50, s44, 4096
buffer_load_dwordx4 v[176:179], v1, s[16:19], s50 offen offset:0 sc1
buffer_load_dwordx4 v[180:183], v1, s[16:19], s50 offen offset:1024 sc1
buffer_load_dwordx4 v[184:187], v1, s[16:19], s50 offen offset:2048 sc1
buffer_load_dwordx4 v[188:191], v1, s[16:19], s50 offen offset:3072 sc1
L_p3_havep1:
v_and_b32 v20, 15, v0
v_lshrrev_b32 v29, 4, v0
v_lshlrev_b32 v2, 12, v20
v_and_b32 v3, 1, v29
v_lshlrev_b32 v3, 5, v3
v_add_u32 v2, v2, v3
v_lshrrev_b32 v3, 1, v29
v_lshlrev_b32 v3, 4, v3
v_add_u32 v2, v2, v3
s_lshl_b32 s50, s29, 17
s_lshl_b32 s51, s30, 7
s_add_u32 s50, s50, s51
v_add_u32 v2, s50, v2
s_lshl_b32 s60, s34, 18
s_lshl_b32 s51, s35, 8
s_add_u32 s60, s60, s51
s_add_u32 s61, s60, 65536
s_waitcnt vmcnt(0)
v_lshlrev_b32 v232, 16, v160
v_and_b32 v233, 0xffff0000, v160
v_lshlrev_b32 v234, 16, v161
v_and_b32 v235, 0xffff0000, v161
v_pk_fma_f32 v[32:33], v[32:33], v[24:25], v[96:97] op_sel:[0,1,0] op_sel_hi:[1,1,1]
v_pk_fma_f32 v[34:35], v[34:35], v[24:25], v[98:99] op_sel:[0,1,0] op_sel_hi:[1,1,1]
v_lshlrev_b32 v236, 16, v168
v_and_b32 v237, 0xffff0000, v168
v_lshlrev_b32 v238, 16, v169
v_and_b32 v239, 0xffff0000, v169
v_pk_fma_f32 v[48:49], v[48:49], v[24:25], v[112:113] op_sel:[0,1,0] op_sel_hi:[1,1,1]
v_pk_fma_f32 v[50:51], v[50:51], v[24:25], v[114:115] op_sel:[0,1,0] op_sel_hi:[1,1,1]
v_pk_add_f32 v[32:33], v[32:33], v[232:233]
v_pk_add_f32 v[34:35], v[34:35], v[234:235]
v_pk_add_f32 v[48:49], v[48:49], v[236:237]
v_pk_add_f32 v[50:51], v[50:51], v[238:239]
v_lshlrev_b32 v224, 16, v162
v_and_b32 v225, 0xffff0000, v162
v_lshlrev_b32 v226, 16, v163
v_and_b32 v227, 0xffff0000, v163
v_pk_fma_f32 v[36:37], v[36:37], v[26:27], v[100:101] op_sel:[0,0,0] op_sel_hi:[1,0,1]
v_pk_fma_f32 v[38:39], v[38:39], v[26:27], v[102:103] op_sel:[0,0,0] op_sel_hi:[1,0,1]
v_lshlrev_b32 v228, 16, v170
v_and_b32 v229, 0xffff0000, v170
v_lshlrev_b32 v230, 16, v171
v_and_b32 v231, 0xffff0000, v171
v_pk_fma_f32 v[52:53], v[52:53], v[26:27], v[116:117] op_sel:[0,0,0] op_sel_hi:[1,0,1]
v_pk_fma_f32 v[54:55], v[54:55], v[26:27], v[118:119] op_sel:[0,0,0] op_sel_hi:[1,0,1]
v_cvt_pk_bf16_f32 v240, v32, v33
v_cvt_pk_bf16_f32 v241, v34, v35
v_cvt_pk_bf16_f32 v242, v48, v49
v_cvt_pk_bf16_f32 v243, v50, v51
v_pk_add_f32 v[36:37], v[36:37], v[224:225]
v_pk_add_f32 v[38:39], v[38:39], v[226:227]
v_pk_add_f32 v[52:53], v[52:53], v[228:229]
v_pk_add_f32 v[54:55], v[54:55], v[230:231]
v_cvt_pk_bf16_f32 v244, v36, v37
v_cvt_pk_bf16_f32 v245, v38, v39
v_cvt_pk_bf16_f32 v246, v52, v53
v_cvt_pk_bf16_f32 v247, v54, v55
v_permlane16_swap_b32 v240, v242
v_permlane16_swap_b32 v241, v243
buffer_store_dwordx4 v[240:243], v2, s[24:27], s60 offen offset:0 sc0 sc1
v_permlane16_swap_b32 v244, v246
v_permlane16_swap_b32 v245, v247
buffer_store_dwordx4 v[244:247], v2, s[24:27], s60 offen offset:2048 sc0 sc1
v_lshlrev_b32 v232, 16, v164
v_and_b32 v233, 0xffff0000, v164
v_lshlrev_b32 v234, 16, v165
v_and_b32 v235, 0xffff0000, v165
v_pk_fma_f32 v[40:41], v[40:41], v[26:27], v[104:105] op_sel:[0,1,0] op_sel_hi:[1,1,1]
v_pk_fma_f32 v[42:43], v[42:43], v[26:27], v[106:107] op_sel:[0,1,0] op_sel_hi:[1,1,1]
v_lshlrev_b32 v236, 16, v172
v_and_b32 v237, 0xffff0000, v172
v_lshlrev_b32 v238, 16, v173
v_and_b32 v239, 0xffff0000, v173
v_pk_fma_f32 v[56:57], v[56:57], v[26:27], v[120:121] op_sel:[0,1,0] op_sel_hi:[1,1,1]
v_pk_fma_f32 v[58:59], v[58:59], v[26:27], v[122:123] op_sel:[0,1,0] op_sel_hi:[1,1,1]
v_pk_add_f32 v[40:41], v[40:41], v[232:233]
v_pk_add_f32 v[42:43], v[42:43], v[234:235]
v_pk_add_f32 v[56:57], v[56:57], v[236:237]
v_pk_add_f32 v[58:59], v[58:59], v[238:239]
v_lshlrev_b32 v224, 16, v166
v_and_b32 v225, 0xffff0000, v166
v_lshlrev_b32 v226, 16, v167
v_and_b32 v227, 0xffff0000, v167
v_pk_fma_f32 v[44:45], v[44:45], v[28:29], v[108:109] op_sel:[0,0,0] op_sel_hi:[1,0,1]
v_pk_fma_f32 v[46:47], v[46:47], v[28:29], v[110:111] op_sel:[0,0,0] op_sel_hi:[1,0,1]
v_lshlrev_b32 v228, 16, v174
v_and_b32 v229, 0xffff0000, v174
v_lshlrev_b32 v230, 16, v175
v_and_b32 v231, 0xffff0000, v175
v_pk_fma_f32 v[60:61], v[60:61], v[28:29], v[124:125] op_sel:[0,0,0] op_sel_hi:[1,0,1]
v_pk_fma_f32 v[62:63], v[62:63], v[28:29], v[126:127] op_sel:[0,0,0] op_sel_hi:[1,0,1]
v_cvt_pk_bf16_f32 v248, v40, v41
v_cvt_pk_bf16_f32 v249, v42, v43
v_cvt_pk_bf16_f32 v250, v56, v57
v_cvt_pk_bf16_f32 v251, v58, v59
v_pk_add_f32 v[44:45], v[44:45], v[224:225]
v_pk_add_f32 v[46:47], v[46:47], v[226:227]
v_pk_add_f32 v[60:61], v[60:61], v[228:229]
v_pk_add_f32 v[62:63], v[62:63], v[230:231]
v_cvt_pk_bf16_f32 v252, v44, v45
v_cvt_pk_bf16_f32 v253, v46, v47
v_cvt_pk_bf16_f32 v254, v60, v61
v_cvt_pk_bf16_f32 v255, v62, v63
v_permlane16_swap_b32 v248, v250
v_permlane16_swap_b32 v249, v251
buffer_store_dwordx4 v[248:251], v2, s[24:27], s61 offen offset:0 sc0 sc1
v_permlane16_swap_b32 v252, v254
v_permlane16_swap_b32 v253, v255
buffer_store_dwordx4 v[252:255], v2, s[24:27], s61 offen offset:2048 sc0 sc1
v_lshlrev_b32 v232, 16, v176
v_and_b32 v233, 0xffff0000, v176
v_lshlrev_b32 v234, 16, v177
v_and_b32 v235, 0xffff0000, v177
v_pk_fma_f32 v[64:65], v[64:65], v[24:25], v[128:129] op_sel:[0,1,0] op_sel_hi:[1,1,1]
v_pk_fma_f32 v[66:67], v[66:67], v[24:25], v[130:131] op_sel:[0,1,0] op_sel_hi:[1,1,1]
v_lshlrev_b32 v236, 16, v184
v_and_b32 v237, 0xffff0000, v184
v_lshlrev_b32 v238, 16, v185
v_and_b32 v239, 0xffff0000, v185
v_pk_fma_f32 v[80:81], v[80:81], v[24:25], v[144:145] op_sel:[0,1,0] op_sel_hi:[1,1,1]
v_pk_fma_f32 v[82:83], v[82:83], v[24:25], v[146:147] op_sel:[0,1,0] op_sel_hi:[1,1,1]
v_pk_add_f32 v[64:65], v[64:65], v[232:233]
v_pk_add_f32 v[66:67], v[66:67], v[234:235]
v_pk_add_f32 v[80:81], v[80:81], v[236:237]
v_pk_add_f32 v[82:83], v[82:83], v[238:239]
v_lshlrev_b32 v224, 16, v178
v_and_b32 v225, 0xffff0000, v178
v_lshlrev_b32 v226, 16, v179
v_and_b32 v227, 0xffff0000, v179
v_pk_fma_f32 v[68:69], v[68:69], v[26:27], v[132:133] op_sel:[0,0,0] op_sel_hi:[1,0,1]
v_pk_fma_f32 v[70:71], v[70:71], v[26:27], v[134:135] op_sel:[0,0,0] op_sel_hi:[1,0,1]
v_lshlrev_b32 v228, 16, v186
v_and_b32 v229, 0xffff0000, v186
v_lshlrev_b32 v230, 16, v187
v_and_b32 v231, 0xffff0000, v187
v_pk_fma_f32 v[84:85], v[84:85], v[26:27], v[148:149] op_sel:[0,0,0] op_sel_hi:[1,0,1]
v_pk_fma_f32 v[86:87], v[86:87], v[26:27], v[150:151] op_sel:[0,0,0] op_sel_hi:[1,0,1]
v_cvt_pk_bf16_f32 v240, v64, v65
v_cvt_pk_bf16_f32 v241, v66, v67
v_cvt_pk_bf16_f32 v242, v80, v81
v_cvt_pk_bf16_f32 v243, v82, v83
v_pk_add_f32 v[68:69], v[68:69], v[224:225]
v_pk_add_f32 v[70:71], v[70:71], v[226:227]
v_pk_add_f32 v[84:85], v[84:85], v[228:229]
v_pk_add_f32 v[86:87], v[86:87], v[230:231]
v_cvt_pk_bf16_f32 v244, v68, v69
v_cvt_pk_bf16_f32 v245, v70, v71
v_cvt_pk_bf16_f32 v246, v84, v85
v_cvt_pk_bf16_f32 v247, v86, v87
v_permlane16_swap_b32 v240, v242
v_permlane16_swap_b32 v241, v243
buffer_store_dwordx4 v[240:243], v2, s[24:27], s60 offen offset:64 sc0 sc1
v_permlane16_swap_b32 v244, v246
v_permlane16_swap_b32 v245, v247
buffer_store_dwordx4 v[244:247], v2, s[24:27], s60 offen offset:2112 sc0 sc1
v_lshlrev_b32 v232, 16, v180
v_and_b32 v233, 0xffff0000, v180
v_lshlrev_b32 v234, 16, v181
v_and_b32 v235, 0xffff0000, v181
v_pk_fma_f32 v[72:73], v[72:73], v[26:27], v[136:137] op_sel:[0,1,0] op_sel_hi:[1,1,1]
v_pk_fma_f32 v[74:75], v[74:75], v[26:27], v[138:139] op_sel:[0,1,0] op_sel_hi:[1,1,1]
v_lshlrev_b32 v236, 16, v188
v_and_b32 v237, 0xffff0000, v188
v_lshlrev_b32 v238, 16, v189
v_and_b32 v239, 0xffff0000, v189
v_pk_fma_f32 v[88:89], v[88:89], v[26:27], v[152:153] op_sel:[0,1,0] op_sel_hi:[1,1,1]
v_pk_fma_f32 v[90:91], v[90:91], v[26:27], v[154:155] op_sel:[0,1,0] op_sel_hi:[1,1,1]
v_pk_add_f32 v[72:73], v[72:73], v[232:233]
v_pk_add_f32 v[74:75], v[74:75], v[234:235]
v_pk_add_f32 v[88:89], v[88:89], v[236:237]
v_pk_add_f32 v[90:91], v[90:91], v[238:239]
v_lshlrev_b32 v224, 16, v182
v_and_b32 v225, 0xffff0000, v182
v_lshlrev_b32 v226, 16, v183
v_and_b32 v227, 0xffff0000, v183
v_pk_fma_f32 v[76:77], v[76:77], v[28:29], v[140:141] op_sel:[0,0,0] op_sel_hi:[1,0,1]
v_pk_fma_f32 v[78:79], v[78:79], v[28:29], v[142:143] op_sel:[0,0,0] op_sel_hi:[1,0,1]
v_lshlrev_b32 v228, 16, v190
v_and_b32 v229, 0xffff0000, v190
v_lshlrev_b32 v230, 16, v191
v_and_b32 v231, 0xffff0000, v191
v_pk_fma_f32 v[92:93], v[92:93], v[28:29], v[156:157] op_sel:[0,0,0] op_sel_hi:[1,0,1]
v_pk_fma_f32 v[94:95], v[94:95], v[28:29], v[158:159] op_sel:[0,0,0] op_sel_hi:[1,0,1]
v_cvt_pk_bf16_f32 v248, v72, v73
v_cvt_pk_bf16_f32 v249, v74, v75
v_cvt_pk_bf16_f32 v250, v88, v89
v_cvt_pk_bf16_f32 v251, v90, v91
v_pk_add_f32 v[76:77], v[76:77], v[224:225]
v_pk_add_f32 v[78:79], v[78:79], v[226:227]
v_pk_add_f32 v[92:93], v[92:93], v[228:229]
v_pk_add_f32 v[94:95], v[94:95], v[230:231]
v_cvt_pk_bf16_f32 v252, v76, v77
v_cvt_pk_bf16_f32 v253, v78, v79
v_cvt_pk_bf16_f32 v254, v92, v93
v_cvt_pk_bf16_f32 v255, v94, v95
v_permlane16_swap_b32 v248, v250
v_permlane16_swap_b32 v249, v251
buffer_store_dwordx4 v[248:251], v2, s[24:27], s61 offen offset:64 sc0 sc1
v_permlane16_swap_b32 v252, v254
v_permlane16_swap_b32 v253, v255
buffer_store_dwordx4 v[252:255], v2, s[24:27], s61 offen offset:2112 sc0 sc1
L_fin:
L_exit:
s_endpgm
L_code_end:
.fill 64, 4, 0xbf800000
.section .rodata,"a"
.p2align 6
.amdhsa_kernel gated_mix__sliding_local_dilated__dense_activation_squared_relu__prompt_kernel
  .amdhsa_next_free_vgpr 512
  .amdhsa_next_free_sgpr 102
  .amdhsa_accum_offset 256
  .amdhsa_group_segment_fixed_size 0
  .amdhsa_kernarg_size 96
  .amdhsa_user_sgpr_count 2
  .amdhsa_user_sgpr_kernarg_segment_ptr 1
  .amdhsa_system_sgpr_workgroup_id_x 1
.end_amdhsa_kernel
```
